```python
import torch

def _softmax(x, axis=-1):
    return torch.softmax(x, dim=axis)
def _gelu(x):
    return torch.nn.functional.gelu(x, approximate="tanh")
def _silu(x):
    return torch.nn.functional.silu(x)
def _sigmoid(x):
    return torch.sigmoid(x)
def _layernorm(x, axis=-1, eps=1e-5):
    m = x.mean(dim=axis, keepdim=True)
    v = x.var(dim=axis, keepdim=True, unbiased=False)
    return (x - m) / torch.sqrt(v + eps)
def _scatter_add(tgt, idx, src, axis=0):
    return tgt.clone().index_add_(axis, idx, src)
def _segment_sum(src, seg, n):
    out = torch.zeros((n,) + src.shape[1:], dtype=src.dtype)
    return out.index_add_(0, seg, src)
def _pad(x, pw):
    flat = tuple(v for pair in reversed(pw) for v in pair)
    return torch.nn.functional.pad(x, flat)

kernel_name = 'sequential_preLN__mha_block_cached__dense_activation_squared_relu__decode'

def setup_inputs():

    _w = (lambda a: (lambda t: t.to(torch.bfloat16) if t.is_floating_point() else t)(torch.as_tensor(a)))
    def _A_setup():
        B, Sq, D = 2, 1, 640
        H, Sk, Dh = 32, 8192, 192
        return {
            "x": _w((lambda *s: torch.randn(*s, dtype=torch.bfloat16) * 0.05)(B, Sq, D)),
            "k_cache": _w((lambda *s: torch.randn(*s, dtype=torch.bfloat16) * 3.2)(B, H, Sk, Dh)),
            "v_cache": _w((lambda *s: torch.randn(*s, dtype=torch.bfloat16) * 0.4)(B, H, Sk, Dh)),
            "wq": _w((lambda *s: torch.randn(*s, dtype=torch.bfloat16) * 3.2)(D, H * Dh) * (D ** -0.5)),
            "wo": _w((lambda *s: torch.randn(*s, dtype=torch.bfloat16) * 0.4)(H * Dh, D) * ((H * Dh) ** -0.5)),
        }
    _A_in = _A_setup()

    def _B_setup():
        B, S, D, F = 2, 1, 640, 1536
        return {
            "x": _w((lambda *s: torch.randn(*s, dtype=torch.bfloat16) * 0.05)(B, S, D)),
            "w1": _w((lambda *s: torch.randn(*s, dtype=torch.bfloat16) * 0.05)(D, F)),
            "b1": _w((lambda *s: torch.randn(*s, dtype=torch.bfloat16) * 0.8)(F)),
            "w2": _w((lambda *s: torch.randn(*s, dtype=torch.bfloat16) * 0.05)(F, D)),
            "b2": _w((lambda *s: torch.randn(*s, dtype=torch.bfloat16) * 3.2)(D)),
        }
    _B_in = _B_setup()

    return {
        "A_x": _A_in["x"],
        "A_k_cache": _A_in["k_cache"],
        "A_v_cache": _A_in["v_cache"],
        "A_wq": _A_in["wq"],
        "A_wo": _A_in["wo"],
        "B_x": _B_in["x"],
        "B_w1": _B_in["w1"],
        "B_b1": _B_in["b1"],
        "B_w2": _B_in["w2"],
        "B_b2": _B_in["b2"],
    }

def reference(A_x, A_k_cache, A_v_cache, A_wq, A_wo, B_x, B_w1, B_b1, B_w2, B_b2):
    def _A_ref(x, k_cache, v_cache, wq, wo):
        B, Sq, D = x.shape
        H, Dh = 32, 192
        q = (lambda x, *d: x.permute(*d))((x @ wq).reshape(B, Sq, H, Dh), 0, 2, 1, 3)
        scores = torch.einsum("bhqd,bhkd->bhqk", q, k_cache) * (Dh ** -0.5)
        p = _softmax(scores, axis=-1)
        o = torch.einsum("bhqk,bhkd->bhqd", p, v_cache)
        return (lambda x, *d: x.permute(*d))(o, 0, 2, 1, 3).reshape(B, Sq, H * Dh) @ wo

    def _B_ref(x, w1, b1, w2, b2):
        h = torch.einsum("bsd,df->bsf", x, w1) + b1
        zero = torch.zeros_like(h)
        r = torch.where(h > zero, h, zero)
        h = r * r
        out = torch.einsum("bsf,fd->bsd", h, w2) + b2
        return out

    x = A_x
    h = x + _A_ref(_layernorm(x, axis=-1), A_k_cache, A_v_cache, A_wq, A_wo)
    h2 = h + _B_ref(_layernorm(h, axis=-1), B_w1, B_b1, B_w2, B_b2)
    return h2
```

```asm
; @launch kernel=attn_kernel grid=(256,1,1) block=(1024,1,1) lds=98304
; @launch kernel=tail_kernel grid=(228,1,1) block=(384,1,1) lds=53248
.amdgcn_target "amdgcn-amd-amdhsa--gfx950"
.text
.p2align 8
.type attn_kernel,@function
attn_kernel:
    s_cmp_ge_u32 s2, 256
    s_cbranch_scc1 attn_end
    s_load_dwordx2 s[4:5], s[0:1], 0
    s_load_dwordx4 s[8:11], s[0:1], 8
    s_load_dwordx2 s[12:13], s[0:1], 24
    s_load_dwordx2 s[14:15], s[0:1], 96
    v_and_b32 v1, 63, v0
    v_and_b32 v2, 31, v0
    v_bfe_u32 v3, v0, 5, 1
    v_lshrrev_b32 v5, 6, v0
    s_nop 0
    v_readfirstlane_b32 s36, v5
    s_and_b32 s40, s2, 7
    s_lshr_b32 s41, s2, 3
    s_lshl_b32 s37, s40, 2
    s_and_b32 s40, s41, 3
    s_add_u32 s37, s37, s40
    s_lshr_b32 s41, s41, 2
    s_lshr_b32 s38, s41, 2
    s_and_b32 s39, s41, 3
    s_lshl_b32 s51, s38, 5
    s_add_u32 s51, s51, s37
    s_lshl_b32 s51, s51, 2
    s_add_u32 s51, s51, s39
    s_mul_i32 s42, s51, 786432
    s_mov_b32 s44, 0x05040100
    s_mov_b32 s45, 0x07060302
    s_mov_b32 s46, 0xcccccccc
    s_mov_b32 s47, 0xcccccccc
    s_mov_b32 s48, 0xaaaaaaaa
    s_mov_b32 s49, 0xaaaaaaaa
    s_mul_i32 s50, s36, 491520
    s_mul_i32 s40, s37, 384
    s_add_u32 s50, s50, s40
    s_mul_i32 s52, s36, 24576
    s_add_u32 s52, s52, s42
    v_mul_u32_u24 v30, 12, v2
    v_mul_u32_u24 v4, 384, v3
    v_add_u32 v4, v4, v30
    v_mul_u32_u24 v42, 245760, v3
    v_add_u32 v42, v42, v30
    v_lshlrev_b32 v5, 2, v1
    v_mov_b32 v30, 16
    v_mov_b32 v31, 0
    ds_write_b32 v31, v30 offset:3328
    s_waitcnt lgkmcnt(0)
    s_mov_b32 s16, s4
    s_and_b32 s17, s5, 0xffff
    s_mov_b32 s18, 2560
    s_mov_b32 s19, 0x00020000
    s_mov_b32 s28, s12
    s_and_b32 s29, s13, 0xffff
    s_mov_b32 s30, 7864320
    s_mov_b32 s31, 0x00020000
    s_mov_b32 s32, s14
    s_and_b32 s33, s15, 0xffff
    s_mov_b32 s34, 1048576
    s_mov_b32 s35, 0x00020000
    s_cmp_lt_u32 s36, 2
    s_cbranch_scc0 attn_nosent
    s_mul_i32 s40, s2, 72
    v_add_u32 v30, s40, v0
    v_cmp_gt_u32 vcc, 72, v0
    s_mov_b64 s[56:57], vcc
    v_cmp_gt_u32 vcc, 18240, v30
    s_and_b64 s[56:57], s[56:57], vcc
    v_lshlrev_b32 v30, 4, v30
    v_mov_b32 v10, -1
    v_mov_b32 v11, -1
    v_mov_b32 v12, -1
    v_mov_b32 v13, -1
    s_mov_b64 s[58:59], exec
    s_mov_b64 exec, s[56:57]
    s_cbranch_execz attn_sent_done
    s_mov_b32 s40, 262144
    buffer_store_dwordx4 v[10:13], v30, s[32:35], s40 offen
attn_sent_done:
    s_nop 4
    s_mov_b64 exec, s[58:59]
attn_nosent:
    s_nop 4
    s_mul_i32 s40, s38, 1280
    buffer_load_dword v36, v5, s[16:19], s40 offen offset:0
    buffer_load_dword v37, v5, s[16:19], s40 offen offset:256
    buffer_load_dword v38, v5, s[16:19], s40 offen offset:512
    buffer_load_dword v39, v5, s[16:19], s40 offen offset:768
    buffer_load_dword v40, v5, s[16:19], s40 offen offset:1024
    s_add_u32 s43, s50, 0
    buffer_load_dwordx3 v[44:46], v42, s[28:31], s43 offen
    s_add_u32 s43, s50, 12288
    buffer_load_dwordx3 v[48:50], v42, s[28:31], s43 offen
    s_add_u32 s43, s50, 24576
    buffer_load_dwordx3 v[52:54], v42, s[28:31], s43 offen
    s_add_u32 s43, s50, 36864
    buffer_load_dwordx3 v[56:58], v42, s[28:31], s43 offen
    s_add_u32 s43, s50, 49152
    buffer_load_dwordx3 v[60:62], v42, s[28:31], s43 offen
    s_add_u32 s43, s50, 61440
    buffer_load_dwordx3 v[64:66], v42, s[28:31], s43 offen
    s_add_u32 s43, s50, 73728
    buffer_load_dwordx3 v[68:70], v42, s[28:31], s43 offen
    s_add_u32 s43, s50, 86016
    buffer_load_dwordx3 v[72:74], v42, s[28:31], s43 offen
    s_add_u32 s43, s50, 98304
    buffer_load_dwordx3 v[76:78], v42, s[28:31], s43 offen
    s_add_u32 s43, s50, 110592
    buffer_load_dwordx3 v[80:82], v42, s[28:31], s43 offen
    s_add_u32 s43, s50, 122880
    buffer_load_dwordx3 v[84:86], v42, s[28:31], s43 offen
    s_add_u32 s43, s50, 135168
    buffer_load_dwordx3 v[88:90], v42, s[28:31], s43 offen
    s_add_u32 s43, s50, 147456
    buffer_load_dwordx3 v[92:94], v42, s[28:31], s43 offen
    s_add_u32 s43, s50, 159744
    buffer_load_dwordx3 v[96:98], v42, s[28:31], s43 offen
    s_add_u32 s43, s50, 172032
    buffer_load_dwordx3 v[100:102], v42, s[28:31], s43 offen
    s_add_u32 s43, s50, 184320
    buffer_load_dwordx3 v[104:106], v42, s[28:31], s43 offen
    s_add_u32 s43, s50, 196608
    buffer_load_dwordx3 v[108:110], v42, s[28:31], s43 offen
    s_add_u32 s43, s50, 208896
    buffer_load_dwordx3 v[112:114], v42, s[28:31], s43 offen
    s_add_u32 s43, s50, 221184
    buffer_load_dwordx3 v[116:118], v42, s[28:31], s43 offen
    s_add_u32 s43, s50, 233472
    buffer_load_dwordx3 v[120:122], v42, s[28:31], s43 offen
    s_mov_b32 s20, s8
    s_and_b32 s21, s9, 0xffff
    s_mov_b32 s22, 201326592
    s_mov_b32 s23, 0x00020000
    s_mov_b32 s24, s10
    s_and_b32 s25, s11, 0xffff
    s_mov_b32 s26, 201326592
    s_mov_b32 s27, 0x00020000
    s_waitcnt vmcnt(20)
    v_lshlrev_b32 v16, 16, v36
    v_and_b32 v17, 0xffff0000, v36
    v_lshlrev_b32 v18, 16, v37
    v_and_b32 v19, 0xffff0000, v37
    v_lshlrev_b32 v20, 16, v38
    v_and_b32 v21, 0xffff0000, v38
    v_lshlrev_b32 v22, 16, v39
    v_and_b32 v23, 0xffff0000, v39
    v_lshlrev_b32 v24, 16, v40
    v_and_b32 v25, 0xffff0000, v40
    v_add_f32 v28, v16, v17
    v_add_f32 v28, v28, v18
    v_add_f32 v28, v28, v19
    v_add_f32 v28, v28, v20
    v_add_f32 v28, v28, v21
    v_add_f32 v28, v28, v22
    v_add_f32 v28, v28, v23
    v_add_f32 v28, v28, v24
    v_add_f32 v28, v28, v25
    s_nop 1
    v_add_f32_dpp v28, v28, v28 quad_perm:[1,0,3,2] row_mask:0xf bank_mask:0xf
    s_nop 1
    v_add_f32_dpp v28, v28, v28 quad_perm:[2,3,0,1] row_mask:0xf bank_mask:0xf
    s_nop 1
    v_add_f32_dpp v28, v28, v28 row_half_mirror row_mask:0xf bank_mask:0xf
    s_nop 1
    v_add_f32_dpp v28, v28, v28 row_mirror row_mask:0xf bank_mask:0xf
    v_mov_b32 v29, v28
    s_nop 1
    v_permlane16_swap_b32 v28, v29
    v_add_f32 v28, v28, v29
    v_mov_b32 v29, v28
    s_nop 1
    v_permlane32_swap_b32 v28, v29
    v_add_f32 v28, v28, v29
    v_mul_f32 v28, 0x3acccccd, v28
    v_sub_f32 v29, v16, v28
    v_mul_f32 v31, v29, v29
    v_sub_f32 v29, v17, v28
    v_fmac_f32 v31, v29, v29
    v_sub_f32 v29, v18, v28
    v_fmac_f32 v31, v29, v29
    v_sub_f32 v29, v19, v28
    v_fmac_f32 v31, v29, v29
    v_sub_f32 v29, v20, v28
    v_fmac_f32 v31, v29, v29
    v_sub_f32 v29, v21, v28
    v_fmac_f32 v31, v29, v29
    v_sub_f32 v29, v22, v28
    v_fmac_f32 v31, v29, v29
    v_sub_f32 v29, v23, v28
    v_fmac_f32 v31, v29, v29
    v_sub_f32 v29, v24, v28
    v_fmac_f32 v31, v29, v29
    v_sub_f32 v29, v25, v28
    v_fmac_f32 v31, v29, v29
    s_nop 1
    v_add_f32_dpp v31, v31, v31 quad_perm:[1,0,3,2] row_mask:0xf bank_mask:0xf
    s_nop 1
    v_add_f32_dpp v31, v31, v31 quad_perm:[2,3,0,1] row_mask:0xf bank_mask:0xf
    s_nop 1
    v_add_f32_dpp v31, v31, v31 row_half_mirror row_mask:0xf bank_mask:0xf
    s_nop 1
    v_add_f32_dpp v31, v31, v31 row_mirror row_mask:0xf bank_mask:0xf
    v_mov_b32 v29, v31
    s_nop 1
    v_permlane16_swap_b32 v31, v29
    v_add_f32 v31, v31, v29
    v_mov_b32 v29, v31
    s_nop 1
    v_permlane32_swap_b32 v31, v29
    v_add_f32 v31, v31, v29
    v_mul_f32 v31, 0x3acccccd, v31
    v_cvt_pk_bf16_f32 v26, v28, v28
    v_lshlrev_b32 v26, 16, v26
    v_cvt_pk_bf16_f32 v31, v31, v31
    v_lshlrev_b32 v31, 16, v31
    v_add_f32 v31, 0x3727c5ac, v31
    v_cvt_pk_bf16_f32 v31, v31, v31
    v_lshlrev_b32 v31, 16, v31
    v_sqrt_f32 v31, v31
    s_nop 0
    v_cvt_pk_bf16_f32 v27, v31, v31
    v_lshlrev_b32 v27, 16, v27
    v_sub_f32 v16, v16, v26
    v_cvt_pk_bf16_f32 v16, v16, v16
    v_lshlrev_b32 v16, 16, v16
    v_mov_b32 v29, v16
    v_rcp_f32 v28, v27
    s_nop 0
    v_mul_f32 v16, v29, v28
    v_fma_f32 v29, -v16, v27, v29
    v_fma_f32 v16, v29, v28, v16
    v_cvt_pk_bf16_f32 v16, v16, v16
    v_lshlrev_b32 v16, 16, v16
    v_sub_f32 v17, v17, v26
    v_cvt_pk_bf16_f32 v17, v17, v17
    v_lshlrev_b32 v17, 16, v17
    v_mov_b32 v29, v17
    v_rcp_f32 v28, v27
    s_nop 0
    v_mul_f32 v17, v29, v28
    v_fma_f32 v29, -v17, v27, v29
    v_fma_f32 v17, v29, v28, v17
    v_cvt_pk_bf16_f32 v17, v17, v17
    v_lshlrev_b32 v17, 16, v17
    v_sub_f32 v18, v18, v26
    v_cvt_pk_bf16_f32 v18, v18, v18
    v_lshlrev_b32 v18, 16, v18
    v_mov_b32 v29, v18
    v_rcp_f32 v28, v27
    s_nop 0
    v_mul_f32 v18, v29, v28
    v_fma_f32 v29, -v18, v27, v29
    v_fma_f32 v18, v29, v28, v18
    v_cvt_pk_bf16_f32 v18, v18, v18
    v_lshlrev_b32 v18, 16, v18
    v_sub_f32 v19, v19, v26
    v_cvt_pk_bf16_f32 v19, v19, v19
    v_lshlrev_b32 v19, 16, v19
    v_mov_b32 v29, v19
    v_rcp_f32 v28, v27
    s_nop 0
    v_mul_f32 v19, v29, v28
    v_fma_f32 v29, -v19, v27, v29
    v_fma_f32 v19, v29, v28, v19
    v_cvt_pk_bf16_f32 v19, v19, v19
    v_lshlrev_b32 v19, 16, v19
    v_sub_f32 v20, v20, v26
    v_cvt_pk_bf16_f32 v20, v20, v20
    v_lshlrev_b32 v20, 16, v20
    v_mov_b32 v29, v20
    v_rcp_f32 v28, v27
    s_nop 0
    v_mul_f32 v20, v29, v28
    v_fma_f32 v29, -v20, v27, v29
    v_fma_f32 v20, v29, v28, v20
    v_cvt_pk_bf16_f32 v20, v20, v20
    v_lshlrev_b32 v20, 16, v20
    v_sub_f32 v21, v21, v26
    v_cvt_pk_bf16_f32 v21, v21, v21
    v_lshlrev_b32 v21, 16, v21
    v_mov_b32 v29, v21
    v_rcp_f32 v28, v27
    s_nop 0
    v_mul_f32 v21, v29, v28
    v_fma_f32 v29, -v21, v27, v29
    v_fma_f32 v21, v29, v28, v21
    v_cvt_pk_bf16_f32 v21, v21, v21
    v_lshlrev_b32 v21, 16, v21
    v_sub_f32 v22, v22, v26
    v_cvt_pk_bf16_f32 v22, v22, v22
    v_lshlrev_b32 v22, 16, v22
    v_mov_b32 v29, v22
    v_rcp_f32 v28, v27
    s_nop 0
    v_mul_f32 v22, v29, v28
    v_fma_f32 v29, -v22, v27, v29
    v_fma_f32 v22, v29, v28, v22
    v_cvt_pk_bf16_f32 v22, v22, v22
    v_lshlrev_b32 v22, 16, v22
    v_sub_f32 v23, v23, v26
    v_cvt_pk_bf16_f32 v23, v23, v23
    v_lshlrev_b32 v23, 16, v23
    v_mov_b32 v29, v23
    v_rcp_f32 v28, v27
    s_nop 0
    v_mul_f32 v23, v29, v28
    v_fma_f32 v29, -v23, v27, v29
    v_fma_f32 v23, v29, v28, v23
    v_cvt_pk_bf16_f32 v23, v23, v23
    v_lshlrev_b32 v23, 16, v23
    v_sub_f32 v24, v24, v26
    v_cvt_pk_bf16_f32 v24, v24, v24
    v_lshlrev_b32 v24, 16, v24
    v_mov_b32 v29, v24
    v_rcp_f32 v28, v27
    s_nop 0
    v_mul_f32 v24, v29, v28
    v_fma_f32 v29, -v24, v27, v29
    v_fma_f32 v24, v29, v28, v24
    v_cvt_pk_bf16_f32 v24, v24, v24
    v_lshlrev_b32 v24, 16, v24
    v_sub_f32 v25, v25, v26
    v_cvt_pk_bf16_f32 v25, v25, v25
    v_lshlrev_b32 v25, 16, v25
    v_mov_b32 v29, v25
    v_rcp_f32 v28, v27
    s_nop 0
    v_mul_f32 v25, v29, v28
    v_fma_f32 v29, -v25, v27, v29
    v_fma_f32 v25, v29, v28, v25
    v_cvt_pk_bf16_f32 v25, v25, v25
    v_lshlrev_b32 v25, 16, v25
    v_lshlrev_b32 v5, 3, v1
    ds_write_b64 v5, v[16:17] offset:0
    ds_write_b64 v5, v[18:19] offset:512
    ds_write_b64 v5, v[20:21] offset:1024
    ds_write_b64 v5, v[22:23] offset:1536
    ds_write_b64 v5, v[24:25] offset:2048
    v_lshrrev_b32 v5, 5, v0
    v_mul_u32_u24 v5, 80, v5
    s_waitcnt lgkmcnt(0)
    ds_read_b128 v[16:19], v5 offset:0
    ds_read_b128 v[20:23], v5 offset:16
    ds_read_b128 v[24:27], v5 offset:32
    ds_read_b128 v[28:31], v5 offset:48
    ds_read_b128 v[32:35], v5 offset:64
    v_mov_b32 v10, 0
    v_mov_b32 v11, 0
    v_mov_b32 v12, 0
    v_mov_b32 v13, 0
    v_mov_b32 v14, 0
    v_mov_b32 v15, 0
    s_waitcnt lgkmcnt(0)
    s_waitcnt vmcnt(19)
    v_lshlrev_b32 v36, 16, v44
    v_and_b32 v37, 0xffff0000, v44
    v_fmac_f32 v10, v36, v16
    v_fmac_f32 v11, v37, v16
    v_lshlrev_b32 v36, 16, v45
    v_and_b32 v37, 0xffff0000, v45
    v_fmac_f32 v12, v36, v16
    v_fmac_f32 v13, v37, v16
    v_lshlrev_b32 v36, 16, v46
    v_and_b32 v37, 0xffff0000, v46
    v_fmac_f32 v14, v36, v16
    v_fmac_f32 v15, v37, v16
    s_add_u32 s43, s52, 0
    buffer_load_dwordx3 v[44:46], v4, s[20:23], s43 offen nt
    s_waitcnt vmcnt(19)
    v_lshlrev_b32 v36, 16, v48
    v_and_b32 v37, 0xffff0000, v48
    v_fmac_f32 v10, v36, v17
    v_fmac_f32 v11, v37, v17
    v_lshlrev_b32 v36, 16, v49
    v_and_b32 v37, 0xffff0000, v49
    v_fmac_f32 v12, v36, v17
    v_fmac_f32 v13, v37, v17
    v_lshlrev_b32 v36, 16, v50
    v_and_b32 v37, 0xffff0000, v50
    v_fmac_f32 v14, v36, v17
    v_fmac_f32 v15, v37, v17
    s_add_u32 s43, s52, 768
    buffer_load_dwordx3 v[48:50], v4, s[20:23], s43 offen nt
    s_waitcnt vmcnt(19)
    v_lshlrev_b32 v36, 16, v52
    v_and_b32 v37, 0xffff0000, v52
    v_fmac_f32 v10, v36, v18
    v_fmac_f32 v11, v37, v18
    v_lshlrev_b32 v36, 16, v53
    v_and_b32 v37, 0xffff0000, v53
    v_fmac_f32 v12, v36, v18
    v_fmac_f32 v13, v37, v18
    v_lshlrev_b32 v36, 16, v54
    v_and_b32 v37, 0xffff0000, v54
    v_fmac_f32 v14, v36, v18
    v_fmac_f32 v15, v37, v18
    s_add_u32 s43, s52, 1536
    buffer_load_dwordx3 v[52:54], v4, s[20:23], s43 offen nt
    s_waitcnt vmcnt(19)
    v_lshlrev_b32 v36, 16, v56
    v_and_b32 v37, 0xffff0000, v56
    v_fmac_f32 v10, v36, v19
    v_fmac_f32 v11, v37, v19
    v_lshlrev_b32 v36, 16, v57
    v_and_b32 v37, 0xffff0000, v57
    v_fmac_f32 v12, v36, v19
    v_fmac_f32 v13, v37, v19
    v_lshlrev_b32 v36, 16, v58
    v_and_b32 v37, 0xffff0000, v58
    v_fmac_f32 v14, v36, v19
    v_fmac_f32 v15, v37, v19
    s_add_u32 s43, s52, 2304
    buffer_load_dwordx3 v[56:58], v4, s[20:23], s43 offen nt
    s_waitcnt vmcnt(19)
    v_lshlrev_b32 v36, 16, v60
    v_and_b32 v37, 0xffff0000, v60
    v_fmac_f32 v10, v36, v20
    v_fmac_f32 v11, v37, v20
    v_lshlrev_b32 v36, 16, v61
    v_and_b32 v37, 0xffff0000, v61
    v_fmac_f32 v12, v36, v20
    v_fmac_f32 v13, v37, v20
    v_lshlrev_b32 v36, 16, v62
    v_and_b32 v37, 0xffff0000, v62
    v_fmac_f32 v14, v36, v20
    v_fmac_f32 v15, v37, v20
    s_add_u32 s43, s52, 3072
    buffer_load_dwordx3 v[60:62], v4, s[20:23], s43 offen nt
    s_waitcnt vmcnt(19)
    v_lshlrev_b32 v36, 16, v64
    v_and_b32 v37, 0xffff0000, v64
    v_fmac_f32 v10, v36, v21
    v_fmac_f32 v11, v37, v21
    v_lshlrev_b32 v36, 16, v65
    v_and_b32 v37, 0xffff0000, v65
    v_fmac_f32 v12, v36, v21
    v_fmac_f32 v13, v37, v21
    v_lshlrev_b32 v36, 16, v66
    v_and_b32 v37, 0xffff0000, v66
    v_fmac_f32 v14, v36, v21
    v_fmac_f32 v15, v37, v21
    s_add_u32 s43, s52, 3840
    buffer_load_dwordx3 v[64:66], v4, s[20:23], s43 offen nt
    s_waitcnt vmcnt(19)
    v_lshlrev_b32 v36, 16, v68
    v_and_b32 v37, 0xffff0000, v68
    v_fmac_f32 v10, v36, v22
    v_fmac_f32 v11, v37, v22
    v_lshlrev_b32 v36, 16, v69
    v_and_b32 v37, 0xffff0000, v69
    v_fmac_f32 v12, v36, v22
    v_fmac_f32 v13, v37, v22
    v_lshlrev_b32 v36, 16, v70
    v_and_b32 v37, 0xffff0000, v70
    v_fmac_f32 v14, v36, v22
    v_fmac_f32 v15, v37, v22
    s_add_u32 s43, s52, 4608
    buffer_load_dwordx3 v[68:70], v4, s[20:23], s43 offen nt
    s_waitcnt vmcnt(19)
    v_lshlrev_b32 v36, 16, v72
    v_and_b32 v37, 0xffff0000, v72
    v_fmac_f32 v10, v36, v23
    v_fmac_f32 v11, v37, v23
    v_lshlrev_b32 v36, 16, v73
    v_and_b32 v37, 0xffff0000, v73
    v_fmac_f32 v12, v36, v23
    v_fmac_f32 v13, v37, v23
    v_lshlrev_b32 v36, 16, v74
    v_and_b32 v37, 0xffff0000, v74
    v_fmac_f32 v14, v36, v23
    v_fmac_f32 v15, v37, v23
    s_add_u32 s43, s52, 5376
    buffer_load_dwordx3 v[72:74], v4, s[20:23], s43 offen nt
    s_waitcnt vmcnt(19)
    v_lshlrev_b32 v36, 16, v76
    v_and_b32 v37, 0xffff0000, v76
    v_fmac_f32 v10, v36, v24
    v_fmac_f32 v11, v37, v24
    v_lshlrev_b32 v36, 16, v77
    v_and_b32 v37, 0xffff0000, v77
    v_fmac_f32 v12, v36, v24
    v_fmac_f32 v13, v37, v24
    v_lshlrev_b32 v36, 16, v78
    v_and_b32 v37, 0xffff0000, v78
    v_fmac_f32 v14, v36, v24
    v_fmac_f32 v15, v37, v24
    s_add_u32 s43, s52, 6144
    buffer_load_dwordx3 v[76:78], v4, s[20:23], s43 offen nt
    s_waitcnt vmcnt(19)
    v_lshlrev_b32 v36, 16, v80
    v_and_b32 v37, 0xffff0000, v80
    v_fmac_f32 v10, v36, v25
    v_fmac_f32 v11, v37, v25
    v_lshlrev_b32 v36, 16, v81
    v_and_b32 v37, 0xffff0000, v81
    v_fmac_f32 v12, v36, v25
    v_fmac_f32 v13, v37, v25
    v_lshlrev_b32 v36, 16, v82
    v_and_b32 v37, 0xffff0000, v82
    v_fmac_f32 v14, v36, v25
    v_fmac_f32 v15, v37, v25
    s_add_u32 s43, s52, 6912
    buffer_load_dwordx3 v[80:82], v4, s[20:23], s43 offen nt
    s_waitcnt vmcnt(19)
    v_lshlrev_b32 v36, 16, v84
    v_and_b32 v37, 0xffff0000, v84
    v_fmac_f32 v10, v36, v26
    v_fmac_f32 v11, v37, v26
    v_lshlrev_b32 v36, 16, v85
    v_and_b32 v37, 0xffff0000, v85
    v_fmac_f32 v12, v36, v26
    v_fmac_f32 v13, v37, v26
    v_lshlrev_b32 v36, 16, v86
    v_and_b32 v37, 0xffff0000, v86
    v_fmac_f32 v14, v36, v26
    v_fmac_f32 v15, v37, v26
    s_add_u32 s43, s52, 7680
    buffer_load_dwordx3 v[84:86], v4, s[20:23], s43 offen nt
    s_waitcnt vmcnt(19)
    v_lshlrev_b32 v36, 16, v88
    v_and_b32 v37, 0xffff0000, v88
    v_fmac_f32 v10, v36, v27
    v_fmac_f32 v11, v37, v27
    v_lshlrev_b32 v36, 16, v89
    v_and_b32 v37, 0xffff0000, v89
    v_fmac_f32 v12, v36, v27
    v_fmac_f32 v13, v37, v27
    v_lshlrev_b32 v36, 16, v90
    v_and_b32 v37, 0xffff0000, v90
    v_fmac_f32 v14, v36, v27
    v_fmac_f32 v15, v37, v27
    s_add_u32 s43, s52, 8448
    buffer_load_dwordx3 v[88:90], v4, s[20:23], s43 offen nt
    s_waitcnt vmcnt(19)
    v_lshlrev_b32 v36, 16, v92
    v_and_b32 v37, 0xffff0000, v92
    v_fmac_f32 v10, v36, v28
    v_fmac_f32 v11, v37, v28
    v_lshlrev_b32 v36, 16, v93
    v_and_b32 v37, 0xffff0000, v93
    v_fmac_f32 v12, v36, v28
    v_fmac_f32 v13, v37, v28
    v_lshlrev_b32 v36, 16, v94
    v_and_b32 v37, 0xffff0000, v94
    v_fmac_f32 v14, v36, v28
    v_fmac_f32 v15, v37, v28
    s_add_u32 s43, s52, 9216
    buffer_load_dwordx3 v[92:94], v4, s[20:23], s43 offen nt
    s_waitcnt vmcnt(19)
    v_lshlrev_b32 v36, 16, v96
    v_and_b32 v37, 0xffff0000, v96
    v_fmac_f32 v10, v36, v29
    v_fmac_f32 v11, v37, v29
    v_lshlrev_b32 v36, 16, v97
    v_and_b32 v37, 0xffff0000, v97
    v_fmac_f32 v12, v36, v29
    v_fmac_f32 v13, v37, v29
    v_lshlrev_b32 v36, 16, v98
    v_and_b32 v37, 0xffff0000, v98
    v_fmac_f32 v14, v36, v29
    v_fmac_f32 v15, v37, v29
    s_add_u32 s43, s52, 9984
    buffer_load_dwordx3 v[96:98], v4, s[20:23], s43 offen nt
    s_waitcnt vmcnt(19)
    v_lshlrev_b32 v36, 16, v100
    v_and_b32 v37, 0xffff0000, v100
    v_fmac_f32 v10, v36, v30
    v_fmac_f32 v11, v37, v30
    v_lshlrev_b32 v36, 16, v101
    v_and_b32 v37, 0xffff0000, v101
    v_fmac_f32 v12, v36, v30
    v_fmac_f32 v13, v37, v30
    v_lshlrev_b32 v36, 16, v102
    v_and_b32 v37, 0xffff0000, v102
    v_fmac_f32 v14, v36, v30
    v_fmac_f32 v15, v37, v30
    s_add_u32 s43, s52, 10752
    buffer_load_dwordx3 v[100:102], v4, s[20:23], s43 offen nt
    s_waitcnt vmcnt(19)
    v_lshlrev_b32 v36, 16, v104
    v_and_b32 v37, 0xffff0000, v104
    v_fmac_f32 v10, v36, v31
    v_fmac_f32 v11, v37, v31
    v_lshlrev_b32 v36, 16, v105
    v_and_b32 v37, 0xffff0000, v105
    v_fmac_f32 v12, v36, v31
    v_fmac_f32 v13, v37, v31
    v_lshlrev_b32 v36, 16, v106
    v_and_b32 v37, 0xffff0000, v106
    v_fmac_f32 v14, v36, v31
    v_fmac_f32 v15, v37, v31
    s_add_u32 s43, s52, 11520
    buffer_load_dwordx3 v[104:106], v4, s[20:23], s43 offen nt
    s_waitcnt vmcnt(19)
    v_lshlrev_b32 v36, 16, v108
    v_and_b32 v37, 0xffff0000, v108
    v_fmac_f32 v10, v36, v32
    v_fmac_f32 v11, v37, v32
    v_lshlrev_b32 v36, 16, v109
    v_and_b32 v37, 0xffff0000, v109
    v_fmac_f32 v12, v36, v32
    v_fmac_f32 v13, v37, v32
    v_lshlrev_b32 v36, 16, v110
    v_and_b32 v37, 0xffff0000, v110
    v_fmac_f32 v14, v36, v32
    v_fmac_f32 v15, v37, v32
    s_waitcnt vmcnt(18)
    v_lshlrev_b32 v36, 16, v112
    v_and_b32 v37, 0xffff0000, v112
    v_fmac_f32 v10, v36, v33
    v_fmac_f32 v11, v37, v33
    v_lshlrev_b32 v36, 16, v113
    v_and_b32 v37, 0xffff0000, v113
    v_fmac_f32 v12, v36, v33
    v_fmac_f32 v13, v37, v33
    v_lshlrev_b32 v36, 16, v114
    v_and_b32 v37, 0xffff0000, v114
    v_fmac_f32 v14, v36, v33
    v_fmac_f32 v15, v37, v33
    s_waitcnt vmcnt(17)
    v_lshlrev_b32 v36, 16, v116
    v_and_b32 v37, 0xffff0000, v116
    v_fmac_f32 v10, v36, v34
    v_fmac_f32 v11, v37, v34
    v_lshlrev_b32 v36, 16, v117
    v_and_b32 v37, 0xffff0000, v117
    v_fmac_f32 v12, v36, v34
    v_fmac_f32 v13, v37, v34
    v_lshlrev_b32 v36, 16, v118
    v_and_b32 v37, 0xffff0000, v118
    v_fmac_f32 v14, v36, v34
    v_fmac_f32 v15, v37, v34
    s_waitcnt vmcnt(16)
    v_lshlrev_b32 v36, 16, v120
    v_and_b32 v37, 0xffff0000, v120
    v_fmac_f32 v10, v36, v35
    v_fmac_f32 v11, v37, v35
    v_lshlrev_b32 v36, 16, v121
    v_and_b32 v37, 0xffff0000, v121
    v_fmac_f32 v12, v36, v35
    v_fmac_f32 v13, v37, v35
    v_lshlrev_b32 v36, 16, v122
    v_and_b32 v37, 0xffff0000, v122
    v_fmac_f32 v14, v36, v35
    v_fmac_f32 v15, v37, v35
    v_lshrrev_b32 v31, 5, v0
    v_mul_u32_u24 v5, 768, v31
    v_mul_u32_u24 v30, 24, v2
    v_add_u32 v9, v5, v30
    ds_write_b64 v9, v[10:11] offset:8192
    ds_write_b64 v9, v[12:13] offset:8200
    ds_write_b64 v9, v[14:15] offset:8208
    s_waitcnt lgkmcnt(0)
    s_barrier
    s_cmp_lt_u32 s36, 3
    s_cbranch_scc0 attn_q2_skip
    v_lshlrev_b32 v5, 2, v0
    ds_read_b32 v10, v5 offset:8192
    ds_read_b32 v11, v5 offset:8960
    ds_read_b32 v12, v5 offset:9728
    ds_read_b32 v13, v5 offset:10496
    ds_read_b32 v14, v5 offset:11264
    ds_read_b32 v15, v5 offset:12032
    ds_read_b32 v16, v5 offset:12800
    ds_read_b32 v17, v5 offset:13568
    ds_read_b32 v18, v5 offset:14336
    ds_read_b32 v19, v5 offset:15104
    ds_read_b32 v20, v5 offset:15872
    ds_read_b32 v21, v5 offset:16640
    ds_read_b32 v22, v5 offset:17408
    ds_read_b32 v23, v5 offset:18176
    ds_read_b32 v24, v5 offset:18944
    ds_read_b32 v25, v5 offset:19712
    ds_read_b32 v26, v5 offset:20480
    ds_read_b32 v27, v5 offset:21248
    ds_read_b32 v28, v5 offset:22016
    ds_read_b32 v29, v5 offset:22784
    ds_read_b32 v30, v5 offset:23552
    ds_read_b32 v31, v5 offset:24320
    ds_read_b32 v32, v5 offset:25088
    ds_read_b32 v33, v5 offset:25856
    ds_read_b32 v34, v5 offset:26624
    ds_read_b32 v35, v5 offset:27392
    ds_read_b32 v36, v5 offset:28160
    ds_read_b32 v37, v5 offset:28928
    ds_read_b32 v38, v5 offset:29696
    ds_read_b32 v39, v5 offset:30464
    ds_read_b32 v40, v5 offset:31232
    ds_read_b32 v41, v5 offset:32000
    s_waitcnt lgkmcnt(0)
    v_add_f32 v10, v10, v11
    v_add_f32 v12, v12, v13
    v_add_f32 v14, v14, v15
    v_add_f32 v16, v16, v17
    v_add_f32 v18, v18, v19
    v_add_f32 v20, v20, v21
    v_add_f32 v22, v22, v23
    v_add_f32 v24, v24, v25
    v_add_f32 v26, v26, v27
    v_add_f32 v28, v28, v29
    v_add_f32 v30, v30, v31
    v_add_f32 v32, v32, v33
    v_add_f32 v34, v34, v35
    v_add_f32 v36, v36, v37
    v_add_f32 v38, v38, v39
    v_add_f32 v40, v40, v41
    v_add_f32 v10, v10, v12
    v_add_f32 v14, v14, v16
    v_add_f32 v18, v18, v20
    v_add_f32 v22, v22, v24
    v_add_f32 v26, v26, v28
    v_add_f32 v30, v30, v32
    v_add_f32 v34, v34, v36
    v_add_f32 v38, v38, v40
    v_add_f32 v10, v10, v14
    v_add_f32 v18, v18, v22
    v_add_f32 v26, v26, v30
    v_add_f32 v34, v34, v38
    v_add_f32 v10, v10, v18
    v_add_f32 v26, v26, v34
    v_add_f32 v10, v10, v26
    v_cvt_pk_bf16_f32 v10, v10, v10
    v_lshlrev_b32 v5, 1, v0
    ds_write_b16 v5, v10 offset:2560
    s_waitcnt lgkmcnt(0)
attn_q2_skip:
    s_nop 4
    s_barrier
    v_mul_u32_u24 v5, 12, v2
    ds_read_b32 v6, v5 offset:2560
    ds_read_b32 v7, v5 offset:2564
    ds_read_b32 v8, v5 offset:2568
    v_bfrev_b32 v30, v2
    v_lshrrev_b32 v30, 26, v30
    v_lshlrev_b32 v31, 6, v3
    s_lshl_b32 s40, s36, 7
    v_add_u32 v35, s40, v31
    v_add_u32 v34, v35, v30
    v_mov_b32 v10, 0
    v_mov_b32 v11, 0
    v_mov_b32 v12, 0
    v_mov_b32 v13, 0
    v_mov_b32 v14, 0
    v_mov_b32 v15, 0
    v_mov_b32 v18, 0xff800000
    v_mov_b32 v19, 0
    s_waitcnt lgkmcnt(0)
attn_loop:
    s_nop 4
    s_mov_b64 s[56:57], exec
    s_mov_b64 exec, 1
    v_mov_b32 v30, 1
    v_mov_b32 v31, 0
    ds_add_rtn_u32 v17, v31, v30 offset:3328
    s_mov_b64 exec, s[56:57]
    s_waitcnt vmcnt(15)
    v_dot2_f32_bf16 v20, v44, v6, 0
    v_dot2_f32_bf16 v20, v45, v7, v20
    v_dot2_f32_bf16 v20, v46, v8, v20
    s_add_u32 s43, s52, 12288
    buffer_load_dwordx3 v[44:46], v4, s[20:23], s43 offen nt
    s_waitcnt vmcnt(15)
    v_dot2_f32_bf16 v21, v48, v6, 0
    v_dot2_f32_bf16 v21, v49, v7, v21
    v_dot2_f32_bf16 v21, v50, v8, v21
    s_add_u32 s43, s52, 13056
    buffer_load_dwordx3 v[48:50], v4, s[20:23], s43 offen nt
    s_nop 0
    v_permlane16_swap_b32 v20, v21
    v_add_f32 v22, v20, v21
    s_waitcnt vmcnt(15)
    v_dot2_f32_bf16 v20, v52, v6, 0
    v_dot2_f32_bf16 v20, v53, v7, v20
    v_dot2_f32_bf16 v20, v54, v8, v20
    s_add_u32 s43, s52, 13824
    buffer_load_dwordx3 v[52:54], v4, s[20:23], s43 offen nt
    s_waitcnt vmcnt(15)
    v_dot2_f32_bf16 v21, v56, v6, 0
    v_dot2_f32_bf16 v21, v57, v7, v21
    v_dot2_f32_bf16 v21, v58, v8, v21
    s_add_u32 s43, s52, 14592
    buffer_load_dwordx3 v[56:58], v4, s[20:23], s43 offen nt
    s_nop 0
    v_permlane16_swap_b32 v20, v21
    v_add_f32 v23, v20, v21
    v_add_f32_dpp v24, v22, v22 row_ror:8 row_mask:0xf bank_mask:0x3
    s_nop 0
    v_add_f32_dpp v24, v23, v23 row_ror:8 row_mask:0xf bank_mask:0xc
    s_waitcnt vmcnt(15)
    v_dot2_f32_bf16 v20, v60, v6, 0
    v_dot2_f32_bf16 v20, v61, v7, v20
    v_dot2_f32_bf16 v20, v62, v8, v20
    s_add_u32 s43, s52, 15360
    buffer_load_dwordx3 v[60:62], v4, s[20:23], s43 offen nt
    s_waitcnt vmcnt(15)
    v_dot2_f32_bf16 v21, v64, v6, 0
    v_dot2_f32_bf16 v21, v65, v7, v21
    v_dot2_f32_bf16 v21, v66, v8, v21
    s_add_u32 s43, s52, 16128
    buffer_load_dwordx3 v[64:66], v4, s[20:23], s43 offen nt
    s_nop 0
    v_permlane16_swap_b32 v20, v21
    v_add_f32 v22, v20, v21
    s_waitcnt vmcnt(15)
    v_dot2_f32_bf16 v20, v68, v6, 0
    v_dot2_f32_bf16 v20, v69, v7, v20
    v_dot2_f32_bf16 v20, v70, v8, v20
    s_add_u32 s43, s52, 16896
    buffer_load_dwordx3 v[68:70], v4, s[20:23], s43 offen nt
    s_waitcnt vmcnt(15)
    v_dot2_f32_bf16 v21, v72, v6, 0
    v_dot2_f32_bf16 v21, v73, v7, v21
    v_dot2_f32_bf16 v21, v74, v8, v21
    s_add_u32 s43, s52, 17664
    buffer_load_dwordx3 v[72:74], v4, s[20:23], s43 offen nt
    s_nop 0
    v_permlane16_swap_b32 v20, v21
    v_add_f32 v23, v20, v21
    v_add_f32_dpp v25, v22, v22 row_ror:8 row_mask:0xf bank_mask:0x3
    s_nop 0
    v_add_f32_dpp v25, v23, v23 row_ror:8 row_mask:0xf bank_mask:0xc
    v_add_f32_dpp v26, v24, v24 row_shl:4 row_mask:0xf bank_mask:0x5
    s_nop 0
    v_add_f32_dpp v26, v25, v25 row_shr:4 row_mask:0xf bank_mask:0xa
    s_waitcnt vmcnt(15)
    v_dot2_f32_bf16 v20, v76, v6, 0
    v_dot2_f32_bf16 v20, v77, v7, v20
    v_dot2_f32_bf16 v20, v78, v8, v20
    s_add_u32 s43, s52, 18432
    buffer_load_dwordx3 v[76:78], v4, s[20:23], s43 offen nt
    s_waitcnt vmcnt(15)
    v_dot2_f32_bf16 v21, v80, v6, 0
    v_dot2_f32_bf16 v21, v81, v7, v21
    v_dot2_f32_bf16 v21, v82, v8, v21
    s_add_u32 s43, s52, 19200
    buffer_load_dwordx3 v[80:82], v4, s[20:23], s43 offen nt
    s_nop 0
    v_permlane16_swap_b32 v20, v21
    v_add_f32 v22, v20, v21
    s_waitcnt vmcnt(15)
    v_dot2_f32_bf16 v20, v84, v6, 0
    v_dot2_f32_bf16 v20, v85, v7, v20
    v_dot2_f32_bf16 v20, v86, v8, v20
    s_add_u32 s43, s52, 19968
    buffer_load_dwordx3 v[84:86], v4, s[20:23], s43 offen nt
    s_waitcnt vmcnt(15)
    v_dot2_f32_bf16 v21, v88, v6, 0
    v_dot2_f32_bf16 v21, v89, v7, v21
    v_dot2_f32_bf16 v21, v90, v8, v21
    s_add_u32 s43, s52, 20736
    buffer_load_dwordx3 v[88:90], v4, s[20:23], s43 offen nt
    s_nop 0
    v_permlane16_swap_b32 v20, v21
    v_add_f32 v23, v20, v21
    v_add_f32_dpp v24, v22, v22 row_ror:8 row_mask:0xf bank_mask:0x3
    s_nop 0
    v_add_f32_dpp v24, v23, v23 row_ror:8 row_mask:0xf bank_mask:0xc
    s_waitcnt vmcnt(15)
    v_dot2_f32_bf16 v20, v92, v6, 0
    v_dot2_f32_bf16 v20, v93, v7, v20
    v_dot2_f32_bf16 v20, v94, v8, v20
    s_add_u32 s43, s52, 21504
    buffer_load_dwordx3 v[92:94], v4, s[20:23], s43 offen nt
    s_waitcnt vmcnt(15)
    v_dot2_f32_bf16 v21, v96, v6, 0
    v_dot2_f32_bf16 v21, v97, v7, v21
    v_dot2_f32_bf16 v21, v98, v8, v21
    s_add_u32 s43, s52, 22272
    buffer_load_dwordx3 v[96:98], v4, s[20:23], s43 offen nt
    s_nop 0
    v_permlane16_swap_b32 v20, v21
    v_add_f32 v22, v20, v21
    s_waitcnt vmcnt(15)
    v_dot2_f32_bf16 v20, v100, v6, 0
    v_dot2_f32_bf16 v20, v101, v7, v20
    v_dot2_f32_bf16 v20, v102, v8, v20
    s_add_u32 s43, s52, 23040
    buffer_load_dwordx3 v[100:102], v4, s[20:23], s43 offen nt
    s_waitcnt vmcnt(15)
    v_dot2_f32_bf16 v21, v104, v6, 0
    v_dot2_f32_bf16 v21, v105, v7, v21
    v_dot2_f32_bf16 v21, v106, v8, v21
    s_add_u32 s43, s52, 23808
    buffer_load_dwordx3 v[104:106], v4, s[20:23], s43 offen nt
    s_nop 0
    v_permlane16_swap_b32 v20, v21
    v_add_f32 v23, v20, v21
    v_add_f32_dpp v25, v22, v22 row_ror:8 row_mask:0xf bank_mask:0x3
    s_nop 0
    v_add_f32_dpp v25, v23, v23 row_ror:8 row_mask:0xf bank_mask:0xc
    v_add_f32_dpp v27, v24, v24 row_shl:4 row_mask:0xf bank_mask:0x5
    s_nop 0
    v_add_f32_dpp v27, v25, v25 row_shr:4 row_mask:0xf bank_mask:0xa
    v_add_f32_dpp v30, v26, v26 quad_perm:[2,3,0,1] row_mask:0xf bank_mask:0xf
    s_nop 0
    v_add_f32_dpp v31, v27, v27 quad_perm:[2,3,0,1] row_mask:0xf bank_mask:0xf
    v_cndmask_b32 v28, v30, v31, s[46:47]
    s_waitcnt vmcnt(15)
    v_dot2_f32_bf16 v20, v44, v6, 0
    v_dot2_f32_bf16 v20, v45, v7, v20
    v_dot2_f32_bf16 v20, v46, v8, v20
    s_add_u32 s43, s52, 0
    buffer_load_dwordx3 v[44:46], v4, s[24:27], s43 offen nt
    s_waitcnt vmcnt(15)
    v_dot2_f32_bf16 v21, v48, v6, 0
    v_dot2_f32_bf16 v21, v49, v7, v21
    v_dot2_f32_bf16 v21, v50, v8, v21
    s_add_u32 s43, s52, 768
    buffer_load_dwordx3 v[48:50], v4, s[24:27], s43 offen nt
    s_nop 0
    v_permlane16_swap_b32 v20, v21
    v_add_f32 v22, v20, v21
    s_waitcnt vmcnt(15)
    v_dot2_f32_bf16 v20, v52, v6, 0
    v_dot2_f32_bf16 v20, v53, v7, v20
    v_dot2_f32_bf16 v20, v54, v8, v20
    s_add_u32 s43, s52, 1536
    buffer_load_dwordx3 v[52:54], v4, s[24:27], s43 offen nt
    s_waitcnt vmcnt(15)
    v_dot2_f32_bf16 v21, v56, v6, 0
    v_dot2_f32_bf16 v21, v57, v7, v21
    v_dot2_f32_bf16 v21, v58, v8, v21
    s_add_u32 s43, s52, 2304
    buffer_load_dwordx3 v[56:58], v4, s[24:27], s43 offen nt
    s_nop 0
    v_permlane16_swap_b32 v20, v21
    v_add_f32 v23, v20, v21
    v_add_f32_dpp v24, v22, v22 row_ror:8 row_mask:0xf bank_mask:0x3
    s_nop 0
    v_add_f32_dpp v24, v23, v23 row_ror:8 row_mask:0xf bank_mask:0xc
    s_waitcnt vmcnt(15)
    v_dot2_f32_bf16 v20, v60, v6, 0
    v_dot2_f32_bf16 v20, v61, v7, v20
    v_dot2_f32_bf16 v20, v62, v8, v20
    s_add_u32 s43, s52, 3072
    buffer_load_dwordx3 v[60:62], v4, s[24:27], s43 offen nt
    s_waitcnt vmcnt(15)
    v_dot2_f32_bf16 v21, v64, v6, 0
    v_dot2_f32_bf16 v21, v65, v7, v21
    v_dot2_f32_bf16 v21, v66, v8, v21
    s_add_u32 s43, s52, 3840
    buffer_load_dwordx3 v[64:66], v4, s[24:27], s43 offen nt
    s_nop 0
    v_permlane16_swap_b32 v20, v21
    v_add_f32 v22, v20, v21
    s_waitcnt vmcnt(15)
    v_dot2_f32_bf16 v20, v68, v6, 0
    v_dot2_f32_bf16 v20, v69, v7, v20
    v_dot2_f32_bf16 v20, v70, v8, v20
    s_add_u32 s43, s52, 4608
    buffer_load_dwordx3 v[68:70], v4, s[24:27], s43 offen nt
    s_waitcnt vmcnt(15)
    v_dot2_f32_bf16 v21, v72, v6, 0
    v_dot2_f32_bf16 v21, v73, v7, v21
    v_dot2_f32_bf16 v21, v74, v8, v21
    s_add_u32 s43, s52, 5376
    buffer_load_dwordx3 v[72:74], v4, s[24:27], s43 offen nt
    s_nop 0
    v_permlane16_swap_b32 v20, v21
    v_add_f32 v23, v20, v21
    v_add_f32_dpp v25, v22, v22 row_ror:8 row_mask:0xf bank_mask:0x3
    s_nop 0
    v_add_f32_dpp v25, v23, v23 row_ror:8 row_mask:0xf bank_mask:0xc
    v_add_f32_dpp v26, v24, v24 row_shl:4 row_mask:0xf bank_mask:0x5
    s_nop 0
    v_add_f32_dpp v26, v25, v25 row_shr:4 row_mask:0xf bank_mask:0xa
    s_waitcnt vmcnt(15)
    v_dot2_f32_bf16 v20, v76, v6, 0
    v_dot2_f32_bf16 v20, v77, v7, v20
    v_dot2_f32_bf16 v20, v78, v8, v20
    s_add_u32 s43, s52, 6144
    buffer_load_dwordx3 v[76:78], v4, s[24:27], s43 offen nt
    s_waitcnt vmcnt(15)
    v_dot2_f32_bf16 v21, v80, v6, 0
    v_dot2_f32_bf16 v21, v81, v7, v21
    v_dot2_f32_bf16 v21, v82, v8, v21
    s_add_u32 s43, s52, 6912
    buffer_load_dwordx3 v[80:82], v4, s[24:27], s43 offen nt
    s_nop 0
    v_permlane16_swap_b32 v20, v21
    v_add_f32 v22, v20, v21
    s_waitcnt vmcnt(15)
    v_dot2_f32_bf16 v20, v84, v6, 0
    v_dot2_f32_bf16 v20, v85, v7, v20
    v_dot2_f32_bf16 v20, v86, v8, v20
    s_add_u32 s43, s52, 7680
    buffer_load_dwordx3 v[84:86], v4, s[24:27], s43 offen nt
    s_waitcnt vmcnt(15)
    v_dot2_f32_bf16 v21, v88, v6, 0
    v_dot2_f32_bf16 v21, v89, v7, v21
    v_dot2_f32_bf16 v21, v90, v8, v21
    s_add_u32 s43, s52, 8448
    buffer_load_dwordx3 v[88:90], v4, s[24:27], s43 offen nt
    s_nop 0
    v_permlane16_swap_b32 v20, v21
    v_add_f32 v23, v20, v21
    v_add_f32_dpp v24, v22, v22 row_ror:8 row_mask:0xf bank_mask:0x3
    s_nop 0
    v_add_f32_dpp v24, v23, v23 row_ror:8 row_mask:0xf bank_mask:0xc
    s_waitcnt vmcnt(15)
    v_dot2_f32_bf16 v20, v92, v6, 0
    v_dot2_f32_bf16 v20, v93, v7, v20
    v_dot2_f32_bf16 v20, v94, v8, v20
    s_add_u32 s43, s52, 9216
    buffer_load_dwordx3 v[92:94], v4, s[24:27], s43 offen nt
    s_waitcnt vmcnt(15)
    v_dot2_f32_bf16 v21, v96, v6, 0
    v_dot2_f32_bf16 v21, v97, v7, v21
    v_dot2_f32_bf16 v21, v98, v8, v21
    s_add_u32 s43, s52, 9984
    buffer_load_dwordx3 v[96:98], v4, s[24:27], s43 offen nt
    s_nop 0
    v_permlane16_swap_b32 v20, v21
    v_add_f32 v22, v20, v21
    s_waitcnt vmcnt(15)
    v_dot2_f32_bf16 v20, v100, v6, 0
    v_dot2_f32_bf16 v20, v101, v7, v20
    v_dot2_f32_bf16 v20, v102, v8, v20
    s_add_u32 s43, s52, 10752
    buffer_load_dwordx3 v[100:102], v4, s[24:27], s43 offen nt
    s_waitcnt vmcnt(15)
    v_dot2_f32_bf16 v21, v104, v6, 0
    v_dot2_f32_bf16 v21, v105, v7, v21
    v_dot2_f32_bf16 v21, v106, v8, v21
    s_add_u32 s43, s52, 11520
    buffer_load_dwordx3 v[104:106], v4, s[24:27], s43 offen nt
    s_nop 0
    v_permlane16_swap_b32 v20, v21
    v_add_f32 v23, v20, v21
    v_add_f32_dpp v25, v22, v22 row_ror:8 row_mask:0xf bank_mask:0x3
    s_nop 0
    v_add_f32_dpp v25, v23, v23 row_ror:8 row_mask:0xf bank_mask:0xc
    v_add_f32_dpp v27, v24, v24 row_shl:4 row_mask:0xf bank_mask:0x5
    s_nop 0
    v_add_f32_dpp v27, v25, v25 row_shr:4 row_mask:0xf bank_mask:0xa
    v_add_f32_dpp v30, v26, v26 quad_perm:[2,3,0,1] row_mask:0xf bank_mask:0xf
    s_nop 0
    v_add_f32_dpp v31, v27, v27 quad_perm:[2,3,0,1] row_mask:0xf bank_mask:0xf
    v_cndmask_b32 v29, v30, v31, s[46:47]
    v_add_f32_dpp v30, v28, v28 quad_perm:[1,0,3,2] row_mask:0xf bank_mask:0xf
    s_nop 0
    v_add_f32_dpp v31, v29, v29 quad_perm:[1,0,3,2] row_mask:0xf bank_mask:0xf
    v_cndmask_b32 v16, v30, v31, s[48:49]
    v_cvt_pk_bf16_f32 v16, v16, v16
    v_lshlrev_b32 v16, 16, v16
    v_mul_f32 v16, 0x3d93cd3a, v16
    v_cvt_pk_bf16_f32 v16, v16, v16
    v_lshlrev_b32 v16, 16, v16
    v_mov_b32 v22, v16
    s_nop 1
    v_max_f32_dpp v22, v22, v22 quad_perm:[1,0,3,2] row_mask:0xf bank_mask:0xf
    s_nop 1
    v_max_f32_dpp v22, v22, v22 quad_perm:[2,3,0,1] row_mask:0xf bank_mask:0xf
    s_nop 1
    v_max_f32_dpp v22, v22, v22 row_half_mirror row_mask:0xf bank_mask:0xf
    s_nop 1
    v_max_f32_dpp v22, v22, v22 row_mirror row_mask:0xf bank_mask:0xf
    v_mov_b32 v30, v22
    s_nop 1
    v_permlane16_swap_b32 v22, v30
    v_max_f32 v22, v22, v30
    v_mov_b32 v30, v22
    s_nop 1
    v_permlane32_swap_b32 v22, v30
    v_max_f32 v22, v22, v30
    v_max_f32 v22, v22, v18
    v_sub_f32 v23, v18, v22
    v_mul_f32 v23, 0x3fb8aa3b, v23
    v_exp_f32 v23, v23
    v_sub_f32 v16, v16, v22
    v_mul_f32 v16, 0x3fb8aa3b, v16
    v_exp_f32 v16, v16
    v_mov_b32 v18, v22
    v_fma_f32 v19, v19, v23, v16
    v_cvt_pk_bf16_f32 v5, v16, v16
    ds_write_b16 v34, v5 offset:4096
    v_mul_f32 v10, v10, v23
    v_mul_f32 v11, v11, v23
    v_mul_f32 v12, v12, v23
    v_mul_f32 v13, v13, v23
    v_mul_f32 v14, v14, v23
    v_mul_f32 v15, v15, v23
    s_waitcnt lgkmcnt(0)
    ds_read_b128 v[36:39], v35 offset:4096
    ds_read_b128 v[40:43], v35 offset:4112
    v_readfirstlane_b32 s54, v17
    s_mul_i32 s53, s54, 24576
    s_add_u32 s53, s53, s42
    s_cmp_lt_u32 s54, 32
    s_cselect_b32 s53, s53, 0x80000000
    s_waitcnt lgkmcnt(1)
    s_waitcnt vmcnt(14)
    v_perm_b32 v32, v48, v44, s44
    v_perm_b32 v33, v48, v44, s45
    v_dot2_f32_bf16 v10, v32, v36, v10
    v_dot2_f32_bf16 v11, v33, v36, v11
    v_perm_b32 v32, v49, v45, s44
    v_perm_b32 v33, v49, v45, s45
    v_dot2_f32_bf16 v12, v32, v36, v12
    v_dot2_f32_bf16 v13, v33, v36, v13
    v_perm_b32 v32, v50, v46, s44
    v_perm_b32 v33, v50, v46, s45
    v_dot2_f32_bf16 v14, v32, v36, v14
    v_dot2_f32_bf16 v15, v33, v36, v15
    s_add_u32 s43, s52, 12288
    buffer_load_dwordx3 v[44:46], v4, s[24:27], s43 offen nt
    s_add_u32 s43, s52, 13056
    buffer_load_dwordx3 v[48:50], v4, s[24:27], s43 offen nt
    s_waitcnt vmcnt(14)
    v_perm_b32 v32, v56, v52, s44
    v_perm_b32 v33, v56, v52, s45
    v_dot2_f32_bf16 v10, v32, v37, v10
    v_dot2_f32_bf16 v11, v33, v37, v11
    v_perm_b32 v32, v57, v53, s44
    v_perm_b32 v33, v57, v53, s45
    v_dot2_f32_bf16 v12, v32, v37, v12
    v_dot2_f32_bf16 v13, v33, v37, v13
    v_perm_b32 v32, v58, v54, s44
    v_perm_b32 v33, v58, v54, s45
    v_dot2_f32_bf16 v14, v32, v37, v14
    v_dot2_f32_bf16 v15, v33, v37, v15
    s_add_u32 s43, s52, 13824
    buffer_load_dwordx3 v[52:54], v4, s[24:27], s43 offen nt
    s_add_u32 s43, s52, 14592
    buffer_load_dwordx3 v[56:58], v4, s[24:27], s43 offen nt
    s_waitcnt vmcnt(14)
    v_perm_b32 v32, v64, v60, s44
    v_perm_b32 v33, v64, v60, s45
    v_dot2_f32_bf16 v10, v32, v38, v10
    v_dot2_f32_bf16 v11, v33, v38, v11
    v_perm_b32 v32, v65, v61, s44
    v_perm_b32 v33, v65, v61, s45
    v_dot2_f32_bf16 v12, v32, v38, v12
    v_dot2_f32_bf16 v13, v33, v38, v13
    v_perm_b32 v32, v66, v62, s44
    v_perm_b32 v33, v66, v62, s45
    v_dot2_f32_bf16 v14, v32, v38, v14
    v_dot2_f32_bf16 v15, v33, v38, v15
    s_add_u32 s43, s52, 15360
    buffer_load_dwordx3 v[60:62], v4, s[24:27], s43 offen nt
    s_add_u32 s43, s52, 16128
    buffer_load_dwordx3 v[64:66], v4, s[24:27], s43 offen nt
    s_waitcnt vmcnt(14)
    v_perm_b32 v32, v72, v68, s44
    v_perm_b32 v33, v72, v68, s45
    v_dot2_f32_bf16 v10, v32, v39, v10
    v_dot2_f32_bf16 v11, v33, v39, v11
    v_perm_b32 v32, v73, v69, s44
    v_perm_b32 v33, v73, v69, s45
    v_dot2_f32_bf16 v12, v32, v39, v12
    v_dot2_f32_bf16 v13, v33, v39, v13
    v_perm_b32 v32, v74, v70, s44
    v_perm_b32 v33, v74, v70, s45
    v_dot2_f32_bf16 v14, v32, v39, v14
    v_dot2_f32_bf16 v15, v33, v39, v15
    s_add_u32 s43, s52, 16896
    buffer_load_dwordx3 v[68:70], v4, s[24:27], s43 offen nt
    s_add_u32 s43, s52, 17664
    buffer_load_dwordx3 v[72:74], v4, s[24:27], s43 offen nt
    ds_read_b128 v[36:39], v35 offset:4128
    s_waitcnt lgkmcnt(1)
    s_waitcnt vmcnt(14)
    v_perm_b32 v32, v80, v76, s44
    v_perm_b32 v33, v80, v76, s45
    v_dot2_f32_bf16 v10, v32, v40, v10
    v_dot2_f32_bf16 v11, v33, v40, v11
    v_perm_b32 v32, v81, v77, s44
    v_perm_b32 v33, v81, v77, s45
    v_dot2_f32_bf16 v12, v32, v40, v12
    v_dot2_f32_bf16 v13, v33, v40, v13
    v_perm_b32 v32, v82, v78, s44
    v_perm_b32 v33, v82, v78, s45
    v_dot2_f32_bf16 v14, v32, v40, v14
    v_dot2_f32_bf16 v15, v33, v40, v15
    s_add_u32 s43, s52, 18432
    buffer_load_dwordx3 v[76:78], v4, s[24:27], s43 offen nt
    s_add_u32 s43, s52, 19200
    buffer_load_dwordx3 v[80:82], v4, s[24:27], s43 offen nt
    s_waitcnt vmcnt(14)
    v_perm_b32 v32, v88, v84, s44
    v_perm_b32 v33, v88, v84, s45
    v_dot2_f32_bf16 v10, v32, v41, v10
    v_dot2_f32_bf16 v11, v33, v41, v11
    v_perm_b32 v32, v89, v85, s44
    v_perm_b32 v33, v89, v85, s45
    v_dot2_f32_bf16 v12, v32, v41, v12
    v_dot2_f32_bf16 v13, v33, v41, v13
    v_perm_b32 v32, v90, v86, s44
    v_perm_b32 v33, v90, v86, s45
    v_dot2_f32_bf16 v14, v32, v41, v14
    v_dot2_f32_bf16 v15, v33, v41, v15
    s_add_u32 s43, s52, 19968
    buffer_load_dwordx3 v[84:86], v4, s[24:27], s43 offen nt
    s_add_u32 s43, s52, 20736
    buffer_load_dwordx3 v[88:90], v4, s[24:27], s43 offen nt
    s_waitcnt vmcnt(14)
    v_perm_b32 v32, v96, v92, s44
    v_perm_b32 v33, v96, v92, s45
    v_dot2_f32_bf16 v10, v32, v42, v10
    v_dot2_f32_bf16 v11, v33, v42, v11
    v_perm_b32 v32, v97, v93, s44
    v_perm_b32 v33, v97, v93, s45
    v_dot2_f32_bf16 v12, v32, v42, v12
    v_dot2_f32_bf16 v13, v33, v42, v13
    v_perm_b32 v32, v98, v94, s44
    v_perm_b32 v33, v98, v94, s45
    v_dot2_f32_bf16 v14, v32, v42, v14
    v_dot2_f32_bf16 v15, v33, v42, v15
    s_add_u32 s43, s52, 21504
    buffer_load_dwordx3 v[92:94], v4, s[24:27], s43 offen nt
    s_add_u32 s43, s52, 22272
    buffer_load_dwordx3 v[96:98], v4, s[24:27], s43 offen nt
    s_waitcnt vmcnt(14)
    v_perm_b32 v32, v104, v100, s44
    v_perm_b32 v33, v104, v100, s45
    v_dot2_f32_bf16 v10, v32, v43, v10
    v_dot2_f32_bf16 v11, v33, v43, v11
    v_perm_b32 v32, v105, v101, s44
    v_perm_b32 v33, v105, v101, s45
    v_dot2_f32_bf16 v12, v32, v43, v12
    v_dot2_f32_bf16 v13, v33, v43, v13
    v_perm_b32 v32, v106, v102, s44
    v_perm_b32 v33, v106, v102, s45
    v_dot2_f32_bf16 v14, v32, v43, v14
    v_dot2_f32_bf16 v15, v33, v43, v15
    s_add_u32 s43, s52, 23040
    buffer_load_dwordx3 v[100:102], v4, s[24:27], s43 offen nt
    s_add_u32 s43, s52, 23808
    buffer_load_dwordx3 v[104:106], v4, s[24:27], s43 offen nt
    ds_read_b128 v[40:43], v35 offset:4144
    s_waitcnt lgkmcnt(1)
    s_waitcnt vmcnt(14)
    v_perm_b32 v32, v48, v44, s44
    v_perm_b32 v33, v48, v44, s45
    v_dot2_f32_bf16 v10, v32, v36, v10
    v_dot2_f32_bf16 v11, v33, v36, v11
    v_perm_b32 v32, v49, v45, s44
    v_perm_b32 v33, v49, v45, s45
    v_dot2_f32_bf16 v12, v32, v36, v12
    v_dot2_f32_bf16 v13, v33, v36, v13
    v_perm_b32 v32, v50, v46, s44
    v_perm_b32 v33, v50, v46, s45
    v_dot2_f32_bf16 v14, v32, v36, v14
    v_dot2_f32_bf16 v15, v33, v36, v15
    s_add_u32 s43, s53, 0
    buffer_load_dwordx3 v[44:46], v4, s[20:23], s43 offen nt
    s_add_u32 s43, s53, 768
    buffer_load_dwordx3 v[48:50], v4, s[20:23], s43 offen nt
    s_waitcnt vmcnt(14)
    v_perm_b32 v32, v56, v52, s44
    v_perm_b32 v33, v56, v52, s45
    v_dot2_f32_bf16 v10, v32, v37, v10
    v_dot2_f32_bf16 v11, v33, v37, v11
    v_perm_b32 v32, v57, v53, s44
    v_perm_b32 v33, v57, v53, s45
    v_dot2_f32_bf16 v12, v32, v37, v12
    v_dot2_f32_bf16 v13, v33, v37, v13
    v_perm_b32 v32, v58, v54, s44
    v_perm_b32 v33, v58, v54, s45
    v_dot2_f32_bf16 v14, v32, v37, v14
    v_dot2_f32_bf16 v15, v33, v37, v15
    s_add_u32 s43, s53, 1536
    buffer_load_dwordx3 v[52:54], v4, s[20:23], s43 offen nt
    s_add_u32 s43, s53, 2304
    buffer_load_dwordx3 v[56:58], v4, s[20:23], s43 offen nt
    s_waitcnt vmcnt(14)
    v_perm_b32 v32, v64, v60, s44
    v_perm_b32 v33, v64, v60, s45
    v_dot2_f32_bf16 v10, v32, v38, v10
    v_dot2_f32_bf16 v11, v33, v38, v11
    v_perm_b32 v32, v65, v61, s44
    v_perm_b32 v33, v65, v61, s45
    v_dot2_f32_bf16 v12, v32, v38, v12
    v_dot2_f32_bf16 v13, v33, v38, v13
    v_perm_b32 v32, v66, v62, s44
    v_perm_b32 v33, v66, v62, s45
    v_dot2_f32_bf16 v14, v32, v38, v14
    v_dot2_f32_bf16 v15, v33, v38, v15
    s_add_u32 s43, s53, 3072
    buffer_load_dwordx3 v[60:62], v4, s[20:23], s43 offen nt
    s_add_u32 s43, s53, 3840
    buffer_load_dwordx3 v[64:66], v4, s[20:23], s43 offen nt
    s_waitcnt vmcnt(14)
    v_perm_b32 v32, v72, v68, s44
    v_perm_b32 v33, v72, v68, s45
    v_dot2_f32_bf16 v10, v32, v39, v10
    v_dot2_f32_bf16 v11, v33, v39, v11
    v_perm_b32 v32, v73, v69, s44
    v_perm_b32 v33, v73, v69, s45
    v_dot2_f32_bf16 v12, v32, v39, v12
    v_dot2_f32_bf16 v13, v33, v39, v13
    v_perm_b32 v32, v74, v70, s44
    v_perm_b32 v33, v74, v70, s45
    v_dot2_f32_bf16 v14, v32, v39, v14
    v_dot2_f32_bf16 v15, v33, v39, v15
    s_add_u32 s43, s53, 4608
    buffer_load_dwordx3 v[68:70], v4, s[20:23], s43 offen nt
    s_add_u32 s43, s53, 5376
    buffer_load_dwordx3 v[72:74], v4, s[20:23], s43 offen nt
    s_waitcnt lgkmcnt(0)
    s_waitcnt vmcnt(14)
    v_perm_b32 v32, v80, v76, s44
    v_perm_b32 v33, v80, v76, s45
    v_dot2_f32_bf16 v10, v32, v40, v10
    v_dot2_f32_bf16 v11, v33, v40, v11
    v_perm_b32 v32, v81, v77, s44
    v_perm_b32 v33, v81, v77, s45
    v_dot2_f32_bf16 v12, v32, v40, v12
    v_dot2_f32_bf16 v13, v33, v40, v13
    v_perm_b32 v32, v82, v78, s44
    v_perm_b32 v33, v82, v78, s45
    v_dot2_f32_bf16 v14, v32, v40, v14
    v_dot2_f32_bf16 v15, v33, v40, v15
    s_add_u32 s43, s53, 6144
    buffer_load_dwordx3 v[76:78], v4, s[20:23], s43 offen nt
    s_add_u32 s43, s53, 6912
    buffer_load_dwordx3 v[80:82], v4, s[20:23], s43 offen nt
    s_waitcnt vmcnt(14)
    v_perm_b32 v32, v88, v84, s44
    v_perm_b32 v33, v88, v84, s45
    v_dot2_f32_bf16 v10, v32, v41, v10
    v_dot2_f32_bf16 v11, v33, v41, v11
    v_perm_b32 v32, v89, v85, s44
    v_perm_b32 v33, v89, v85, s45
    v_dot2_f32_bf16 v12, v32, v41, v12
    v_dot2_f32_bf16 v13, v33, v41, v13
    v_perm_b32 v32, v90, v86, s44
    v_perm_b32 v33, v90, v86, s45
    v_dot2_f32_bf16 v14, v32, v41, v14
    v_dot2_f32_bf16 v15, v33, v41, v15
    s_add_u32 s43, s53, 7680
    buffer_load_dwordx3 v[84:86], v4, s[20:23], s43 offen nt
    s_add_u32 s43, s53, 8448
    buffer_load_dwordx3 v[88:90], v4, s[20:23], s43 offen nt
    s_waitcnt vmcnt(14)
    v_perm_b32 v32, v96, v92, s44
    v_perm_b32 v33, v96, v92, s45
    v_dot2_f32_bf16 v10, v32, v42, v10
    v_dot2_f32_bf16 v11, v33, v42, v11
    v_perm_b32 v32, v97, v93, s44
    v_perm_b32 v33, v97, v93, s45
    v_dot2_f32_bf16 v12, v32, v42, v12
    v_dot2_f32_bf16 v13, v33, v42, v13
    v_perm_b32 v32, v98, v94, s44
    v_perm_b32 v33, v98, v94, s45
    v_dot2_f32_bf16 v14, v32, v42, v14
    v_dot2_f32_bf16 v15, v33, v42, v15
    s_add_u32 s43, s53, 9216
    buffer_load_dwordx3 v[92:94], v4, s[20:23], s43 offen nt
    s_add_u32 s43, s53, 9984
    buffer_load_dwordx3 v[96:98], v4, s[20:23], s43 offen nt
    s_waitcnt vmcnt(14)
    v_perm_b32 v32, v104, v100, s44
    v_perm_b32 v33, v104, v100, s45
    v_dot2_f32_bf16 v10, v32, v43, v10
    v_dot2_f32_bf16 v11, v33, v43, v11
    v_perm_b32 v32, v105, v101, s44
    v_perm_b32 v33, v105, v101, s45
    v_dot2_f32_bf16 v12, v32, v43, v12
    v_dot2_f32_bf16 v13, v33, v43, v13
    v_perm_b32 v32, v106, v102, s44
    v_perm_b32 v33, v106, v102, s45
    v_dot2_f32_bf16 v14, v32, v43, v14
    v_dot2_f32_bf16 v15, v33, v43, v15
    s_add_u32 s43, s53, 10752
    buffer_load_dwordx3 v[100:102], v4, s[20:23], s43 offen nt
    s_add_u32 s43, s53, 11520
    buffer_load_dwordx3 v[104:106], v4, s[20:23], s43 offen nt
    s_mov_b32 s52, s53
    s_cmp_lt_u32 s54, 32
    s_cbranch_scc1 attn_loop
    v_add_f32_dpp v19, v19, v19 quad_perm:[1,0,3,2] row_mask:0xf bank_mask:0xf
    s_nop 1
    v_add_f32_dpp v19, v19, v19 quad_perm:[2,3,0,1] row_mask:0xf bank_mask:0xf
    s_nop 1
    v_add_f32_dpp v19, v19, v19 row_half_mirror row_mask:0xf bank_mask:0xf
    s_nop 1
    v_add_f32_dpp v19, v19, v19 row_mirror row_mask:0xf bank_mask:0xf
    v_mov_b32 v30, v19
    s_nop 1
    v_permlane16_swap_b32 v19, v30
    v_add_f32 v19, v19, v30
    v_mov_b32 v30, v19
    s_nop 1
    v_permlane32_swap_b32 v19, v30
    v_add_f32 v19, v19, v30
    ds_write_b64 v9, v[10:11] offset:8192
    ds_write_b64 v9, v[12:13] offset:8200
    ds_write_b64 v9, v[14:15] offset:8208
    s_lshl_b32 s40, s36, 3
    v_mov_b32 v5, s40
    ds_write_b64 v5, v[18:19] offset:3072
    s_waitcnt vmcnt(0) lgkmcnt(0)
    s_barrier
    s_cmp_lt_u32 s36, 3
    s_cbranch_scc0 attn_end
    v_mov_b32 v5, 0
    ds_read_b128 v[44:47], v5 offset:3072
    ds_read_b128 v[48:51], v5 offset:3088
    ds_read_b128 v[52:55], v5 offset:3104
    ds_read_b128 v[56:59], v5 offset:3120
    ds_read_b128 v[60:63], v5 offset:3136
    ds_read_b128 v[64:67], v5 offset:3152
    ds_read_b128 v[68:71], v5 offset:3168
    ds_read_b128 v[72:75], v5 offset:3184
    v_lshlrev_b32 v5, 2, v0
    ds_read_b32 v76, v5 offset:8192
    ds_read_b32 v77, v5 offset:8960
    ds_read_b32 v78, v5 offset:9728
    ds_read_b32 v79, v5 offset:10496
    ds_read_b32 v80, v5 offset:11264
    ds_read_b32 v81, v5 offset:12032
    ds_read_b32 v82, v5 offset:12800
    ds_read_b32 v83, v5 offset:13568
    ds_read_b32 v84, v5 offset:14336
    ds_read_b32 v85, v5 offset:15104
    ds_read_b32 v86, v5 offset:15872
    ds_read_b32 v87, v5 offset:16640
    ds_read_b32 v88, v5 offset:17408
    ds_read_b32 v89, v5 offset:18176
    ds_read_b32 v90, v5 offset:18944
    ds_read_b32 v91, v5 offset:19712
    ds_read_b32 v92, v5 offset:20480
    ds_read_b32 v93, v5 offset:21248
    ds_read_b32 v94, v5 offset:22016
    ds_read_b32 v95, v5 offset:22784
    ds_read_b32 v96, v5 offset:23552
    ds_read_b32 v97, v5 offset:24320
    ds_read_b32 v98, v5 offset:25088
    ds_read_b32 v99, v5 offset:25856
    ds_read_b32 v100, v5 offset:26624
    ds_read_b32 v101, v5 offset:27392
    ds_read_b32 v102, v5 offset:28160
    ds_read_b32 v103, v5 offset:28928
    ds_read_b32 v104, v5 offset:29696
    ds_read_b32 v105, v5 offset:30464
    ds_read_b32 v106, v5 offset:31232
    ds_read_b32 v107, v5 offset:32000
    s_waitcnt lgkmcnt(0)
    v_max_f32 v16, v44, v46
    v_max_f32 v16, v16, v48
    v_max_f32 v16, v16, v50
    v_max_f32 v16, v16, v52
    v_max_f32 v16, v16, v54
    v_max_f32 v16, v16, v56
    v_max_f32 v16, v16, v58
    v_max_f32 v16, v16, v60
    v_max_f32 v16, v16, v62
    v_max_f32 v16, v16, v64
    v_max_f32 v16, v16, v66
    v_max_f32 v16, v16, v68
    v_max_f32 v16, v16, v70
    v_max_f32 v16, v16, v72
    v_max_f32 v16, v16, v74
    v_mov_b32 v17, 0
    v_mov_b32 v18, 0
    v_sub_f32 v19, v44, v16
    v_mul_f32 v19, 0x3fb8aa3b, v19
    v_exp_f32 v19, v19
    v_add_f32 v30, v76, v77
    v_fmac_f32 v17, v19, v45
    v_fmac_f32 v18, v19, v30
    v_sub_f32 v19, v46, v16
    v_mul_f32 v19, 0x3fb8aa3b, v19
    v_exp_f32 v19, v19
    v_add_f32 v30, v78, v79
    v_fmac_f32 v17, v19, v47
    v_fmac_f32 v18, v19, v30
    v_sub_f32 v19, v48, v16
    v_mul_f32 v19, 0x3fb8aa3b, v19
    v_exp_f32 v19, v19
    v_add_f32 v30, v80, v81
    v_fmac_f32 v17, v19, v49
    v_fmac_f32 v18, v19, v30
    v_sub_f32 v19, v50, v16
    v_mul_f32 v19, 0x3fb8aa3b, v19
    v_exp_f32 v19, v19
    v_add_f32 v30, v82, v83
    v_fmac_f32 v17, v19, v51
    v_fmac_f32 v18, v19, v30
    v_sub_f32 v19, v52, v16
    v_mul_f32 v19, 0x3fb8aa3b, v19
    v_exp_f32 v19, v19
    v_add_f32 v30, v84, v85
    v_fmac_f32 v17, v19, v53
    v_fmac_f32 v18, v19, v30
    v_sub_f32 v19, v54, v16
    v_mul_f32 v19, 0x3fb8aa3b, v19
    v_exp_f32 v19, v19
    v_add_f32 v30, v86, v87
    v_fmac_f32 v17, v19, v55
    v_fmac_f32 v18, v19, v30
    v_sub_f32 v19, v56, v16
    v_mul_f32 v19, 0x3fb8aa3b, v19
    v_exp_f32 v19, v19
    v_add_f32 v30, v88, v89
    v_fmac_f32 v17, v19, v57
    v_fmac_f32 v18, v19, v30
    v_sub_f32 v19, v58, v16
    v_mul_f32 v19, 0x3fb8aa3b, v19
    v_exp_f32 v19, v19
    v_add_f32 v30, v90, v91
    v_fmac_f32 v17, v19, v59
    v_fmac_f32 v18, v19, v30
    v_sub_f32 v19, v60, v16
    v_mul_f32 v19, 0x3fb8aa3b, v19
    v_exp_f32 v19, v19
    v_add_f32 v30, v92, v93
    v_fmac_f32 v17, v19, v61
    v_fmac_f32 v18, v19, v30
    v_sub_f32 v19, v62, v16
    v_mul_f32 v19, 0x3fb8aa3b, v19
    v_exp_f32 v19, v19
    v_add_f32 v30, v94, v95
    v_fmac_f32 v17, v19, v63
    v_fmac_f32 v18, v19, v30
    v_sub_f32 v19, v64, v16
    v_mul_f32 v19, 0x3fb8aa3b, v19
    v_exp_f32 v19, v19
    v_add_f32 v30, v96, v97
    v_fmac_f32 v17, v19, v65
    v_fmac_f32 v18, v19, v30
    v_sub_f32 v19, v66, v16
    v_mul_f32 v19, 0x3fb8aa3b, v19
    v_exp_f32 v19, v19
    v_add_f32 v30, v98, v99
    v_fmac_f32 v17, v19, v67
    v_fmac_f32 v18, v19, v30
    v_sub_f32 v19, v68, v16
    v_mul_f32 v19, 0x3fb8aa3b, v19
    v_exp_f32 v19, v19
    v_add_f32 v30, v100, v101
    v_fmac_f32 v17, v19, v69
    v_fmac_f32 v18, v19, v30
    v_sub_f32 v19, v70, v16
    v_mul_f32 v19, 0x3fb8aa3b, v19
    v_exp_f32 v19, v19
    v_add_f32 v30, v102, v103
    v_fmac_f32 v17, v19, v71
    v_fmac_f32 v18, v19, v30
    v_sub_f32 v19, v72, v16
    v_mul_f32 v19, 0x3fb8aa3b, v19
    v_exp_f32 v19, v19
    v_add_f32 v30, v104, v105
    v_fmac_f32 v17, v19, v73
    v_fmac_f32 v18, v19, v30
    v_sub_f32 v19, v74, v16
    v_mul_f32 v19, 0x3fb8aa3b, v19
    v_exp_f32 v19, v19
    v_add_f32 v30, v106, v107
    v_fmac_f32 v17, v19, v75
    v_fmac_f32 v18, v19, v30
    s_mul_i32 s40, s51, 768
    buffer_store_dword v18, v5, s[32:35], s40 offen offset:0
    v_mov_b32 v5, 0
    s_lshl_b32 s40, s51, 3
    s_add_u32 s40, s40, 196608
    buffer_store_dwordx2 v[16:17], v5, s[32:35], s40 offen
attn_end:
    s_endpgm
.p2align 8
.type tail_kernel,@function
tail_kernel:
    s_cmp_ge_u32 s2, 228
    s_cbranch_scc1 tail_end
    s_load_dwordx2 s[14:15], s[0:1], 96
    v_and_b32 v1, 63, v0
    v_lshrrev_b32 v2, 6, v0
    s_nop 0
    v_readfirstlane_b32 s36, v2
    s_cmp_ge_u32 s2, 208
    s_cbranch_scc1 tail_fin
    s_cmp_ge_u32 s2, 160
    s_cbranch_scc1 tail_ffn
    s_load_dwordx2 s[4:5], s[0:1], 32
    s_mul_i32 s24, s2, 3277
    s_lshr_b32 s24, s24, 16
    s_mul_i32 s37, s24, 20
    s_sub_u32 s25, s2, s37
    v_lshrrev_b32 v2, 2, v1
    v_mul_u32_u24 v5, 1280, v2
    v_and_b32 v3, 3, v1
    v_lshlrev_b32 v3, 4, v3
    v_add_u32 v5, v5, v3
    v_cmp_le_u32 vcc, 192, v0
    s_nop 1
    v_cndmask_b32 v40, 0, 1, vcc
    v_mul_u32_u24 v2, 192, v40
    v_sub_u32 v2, v0, v2
    v_mul_u32_u24 v3, 1366, v2
    v_lshrrev_b32 v3, 16, v3
    v_mul_u32_u24 v4, 48, v3
    v_sub_u32 v4, v2, v4
    v_lshlrev_b32 v40, 5, v40
    v_add_u32 v3, v3, v40
    v_lshlrev_b32 v7, 5, v3
    v_mul_u32_u24 v6, 3072, v3
    v_lshlrev_b32 v4, 4, v4
    v_add_u32 v6, v6, v4
    s_waitcnt lgkmcnt(0)
    s_mov_b32 s20, s14
    s_and_b32 s21, s15, 0xffff
    s_mov_b32 s22, 1048576
    s_mov_b32 s23, 0x00020000
    s_mov_b32 s16, s4
    s_and_b32 s17, s5, 0xffff
    s_mov_b32 s18, 7864320
    s_mov_b32 s19, 0x00020000
    s_mul_i32 s37, s24, 12288
    buffer_load_dwordx4 v[44:47], v6, s[20:23], s37 offen offset:0
    buffer_load_dwordx4 v[48:51], v6, s[20:23], s37 offen offset:768
    buffer_load_dwordx4 v[52:55], v6, s[20:23], s37 offen offset:1536
    buffer_load_dwordx4 v[56:59], v6, s[20:23], s37 offen offset:2304
    s_lshl_b32 s37, s24, 7
    s_add_u32 s37, s37, 196608
    buffer_load_dwordx4 v[24:27], v7, s[20:23], s37 offen offset:0
    buffer_load_dwordx4 v[28:31], v7, s[20:23], s37 offen offset:16
    s_barrier
    s_mul_i32 s37, s24, 983040
    s_mul_i32 s38, s36, 163840
    s_add_u32 s37, s37, s38
    s_lshl_b32 s38, s25, 6
    s_add_u32 s37, s37, s38
    s_add_u32 s39, s37, 0
    buffer_load_dwordx4 v[60:63], v5, s[16:19], s39 offen
    s_add_u32 s39, s37, 20480
    buffer_load_dwordx4 v[64:67], v5, s[16:19], s39 offen
    s_add_u32 s39, s37, 40960
    buffer_load_dwordx4 v[68:71], v5, s[16:19], s39 offen
    s_add_u32 s39, s37, 61440
    buffer_load_dwordx4 v[72:75], v5, s[16:19], s39 offen
    s_add_u32 s39, s37, 81920
    buffer_load_dwordx4 v[76:79], v5, s[16:19], s39 offen
    s_add_u32 s39, s37, 102400
    buffer_load_dwordx4 v[80:83], v5, s[16:19], s39 offen
    s_add_u32 s39, s37, 122880
    buffer_load_dwordx4 v[84:87], v5, s[16:19], s39 offen
    s_add_u32 s39, s37, 143360
    buffer_load_dwordx4 v[88:91], v5, s[16:19], s39 offen
    v_mov_b32 v8, 0
    v_mov_b32 v9, 0
    v_mov_b32 v10, 0
    v_mov_b32 v11, 0
    v_mov_b32 v12, 0
    v_mov_b32 v13, 0
    v_mov_b32 v14, 0
    v_mov_b32 v15, 0
    v_mov_b32 v16, 0
    v_mov_b32 v17, 0
    v_mov_b32 v18, 0
    v_mov_b32 v19, 0
    v_mov_b32 v20, 0
    v_mov_b32 v21, 0
    v_mov_b32 v22, 0
    v_mov_b32 v23, 0
    s_waitcnt vmcnt(8)
    v_max_f32 v32, v24, v26
    v_max3_f32 v32, v32, v28, v30
    v_sub_f32 v33, v24, v32
    v_mul_f32 v33, 0x3fb8aa3b, v33
    v_exp_f32 v33, v33
    s_nop 0
    v_mul_f32 v34, v33, v25
    v_mul_f32 v36, v33, v44
    v_mul_f32 v37, v33, v45
    v_mul_f32 v38, v33, v46
    v_mul_f32 v39, v33, v47
    v_sub_f32 v33, v26, v32
    v_mul_f32 v33, 0x3fb8aa3b, v33
    v_exp_f32 v33, v33
    s_nop 0
    v_fmac_f32 v34, v33, v27
    v_fmac_f32 v36, v33, v48
    v_fmac_f32 v37, v33, v49
    v_fmac_f32 v38, v33, v50
    v_fmac_f32 v39, v33, v51
    v_sub_f32 v33, v28, v32
    v_mul_f32 v33, 0x3fb8aa3b, v33
    v_exp_f32 v33, v33
    s_nop 0
    v_fmac_f32 v34, v33, v29
    v_fmac_f32 v36, v33, v52
    v_fmac_f32 v37, v33, v53
    v_fmac_f32 v38, v33, v54
    v_fmac_f32 v39, v33, v55
    v_sub_f32 v33, v30, v32
    v_mul_f32 v33, 0x3fb8aa3b, v33
    v_exp_f32 v33, v33
    s_nop 0
    v_fmac_f32 v34, v33, v31
    v_fmac_f32 v36, v33, v56
    v_fmac_f32 v37, v33, v57
    v_fmac_f32 v38, v33, v58
    v_fmac_f32 v39, v33, v59
    v_rcp_f32 v35, v34
    s_nop 0
    v_mul_f32 v44, v36, v35
    v_fma_f32 v36, -v44, v34, v36
    v_fma_f32 v44, v36, v35, v44
    v_mul_f32 v45, v37, v35
    v_fma_f32 v37, -v45, v34, v37
    v_fma_f32 v45, v37, v35, v45
    v_mul_f32 v46, v38, v35
    v_fma_f32 v38, -v46, v34, v38
    v_fma_f32 v46, v38, v35, v46
    v_mul_f32 v47, v39, v35
    v_fma_f32 v39, -v47, v34, v39
    v_fma_f32 v47, v39, v35, v47
    v_cvt_pk_bf16_f32 v2, v44, v45
    v_lshlrev_b32 v44, 16, v2
    v_and_b32 v45, 0xffff0000, v2
    v_cvt_pk_bf16_f32 v2, v46, v47
    v_lshlrev_b32 v46, 16, v2
    v_and_b32 v47, 0xffff0000, v2
    v_lshlrev_b32 v2, 4, v0
    ds_write_b128 v2, v[44:47] offset:0
    v_lshrrev_b32 v2, 2, v1
    s_lshl_b32 s37, s36, 7
    v_add_u32 v2, s37, v2
    v_lshlrev_b32 v2, 2, v2
    s_waitcnt lgkmcnt(0)
    s_barrier
    ds_read_b32 v92, v2 offset:0
    ds_read_b32 v93, v2 offset:3072
    ds_read_b32 v94, v2 offset:64
    ds_read_b32 v95, v2 offset:3136
    ds_read_b32 v96, v2 offset:128
    ds_read_b32 v97, v2 offset:3200
    ds_read_b32 v98, v2 offset:192
    ds_read_b32 v99, v2 offset:3264
    ds_read_b32 v100, v2 offset:256
    ds_read_b32 v101, v2 offset:3328
    ds_read_b32 v102, v2 offset:320
    ds_read_b32 v103, v2 offset:3392
    ds_read_b32 v104, v2 offset:384
    ds_read_b32 v105, v2 offset:3456
    ds_read_b32 v106, v2 offset:448
    ds_read_b32 v107, v2 offset:3520
    s_waitcnt lgkmcnt(0)
    s_waitcnt vmcnt(7)
    v_lshlrev_b32 v3, 16, v60
    v_and_b32 v4, 0xffff0000, v60
    v_fmac_f32 v8, v3, v92
    v_fmac_f32 v9, v4, v92
    v_fmac_f32 v16, v3, v93
    v_fmac_f32 v17, v4, v93
    v_lshlrev_b32 v3, 16, v61
    v_and_b32 v4, 0xffff0000, v61
    v_fmac_f32 v10, v3, v92
    v_fmac_f32 v11, v4, v92
    v_fmac_f32 v18, v3, v93
    v_fmac_f32 v19, v4, v93
    v_lshlrev_b32 v3, 16, v62
    v_and_b32 v4, 0xffff0000, v62
    v_fmac_f32 v12, v3, v92
    v_fmac_f32 v13, v4, v92
    v_fmac_f32 v20, v3, v93
    v_fmac_f32 v21, v4, v93
    v_lshlrev_b32 v3, 16, v63
    v_and_b32 v4, 0xffff0000, v63
    v_fmac_f32 v14, v3, v92
    v_fmac_f32 v15, v4, v92
    v_fmac_f32 v22, v3, v93
    v_fmac_f32 v23, v4, v93
    s_waitcnt vmcnt(6)
    v_lshlrev_b32 v3, 16, v64
    v_and_b32 v4, 0xffff0000, v64
    v_fmac_f32 v8, v3, v94
    v_fmac_f32 v9, v4, v94
    v_fmac_f32 v16, v3, v95
    v_fmac_f32 v17, v4, v95
    v_lshlrev_b32 v3, 16, v65
    v_and_b32 v4, 0xffff0000, v65
    v_fmac_f32 v10, v3, v94
    v_fmac_f32 v11, v4, v94
    v_fmac_f32 v18, v3, v95
    v_fmac_f32 v19, v4, v95
    v_lshlrev_b32 v3, 16, v66
    v_and_b32 v4, 0xffff0000, v66
    v_fmac_f32 v12, v3, v94
    v_fmac_f32 v13, v4, v94
    v_fmac_f32 v20, v3, v95
    v_fmac_f32 v21, v4, v95
    v_lshlrev_b32 v3, 16, v67
    v_and_b32 v4, 0xffff0000, v67
    v_fmac_f32 v14, v3, v94
    v_fmac_f32 v15, v4, v94
    v_fmac_f32 v22, v3, v95
    v_fmac_f32 v23, v4, v95
    s_waitcnt vmcnt(5)
    v_lshlrev_b32 v3, 16, v68
    v_and_b32 v4, 0xffff0000, v68
    v_fmac_f32 v8, v3, v96
    v_fmac_f32 v9, v4, v96
    v_fmac_f32 v16, v3, v97
    v_fmac_f32 v17, v4, v97
    v_lshlrev_b32 v3, 16, v69
    v_and_b32 v4, 0xffff0000, v69
    v_fmac_f32 v10, v3, v96
    v_fmac_f32 v11, v4, v96
    v_fmac_f32 v18, v3, v97
    v_fmac_f32 v19, v4, v97
    v_lshlrev_b32 v3, 16, v70
    v_and_b32 v4, 0xffff0000, v70
    v_fmac_f32 v12, v3, v96
    v_fmac_f32 v13, v4, v96
    v_fmac_f32 v20, v3, v97
    v_fmac_f32 v21, v4, v97
    v_lshlrev_b32 v3, 16, v71
    v_and_b32 v4, 0xffff0000, v71
    v_fmac_f32 v14, v3, v96
    v_fmac_f32 v15, v4, v96
    v_fmac_f32 v22, v3, v97
    v_fmac_f32 v23, v4, v97
    s_waitcnt vmcnt(4)
    v_lshlrev_b32 v3, 16, v72
    v_and_b32 v4, 0xffff0000, v72
    v_fmac_f32 v8, v3, v98
    v_fmac_f32 v9, v4, v98
    v_fmac_f32 v16, v3, v99
    v_fmac_f32 v17, v4, v99
    v_lshlrev_b32 v3, 16, v73
    v_and_b32 v4, 0xffff0000, v73
    v_fmac_f32 v10, v3, v98
    v_fmac_f32 v11, v4, v98
    v_fmac_f32 v18, v3, v99
    v_fmac_f32 v19, v4, v99
    v_lshlrev_b32 v3, 16, v74
    v_and_b32 v4, 0xffff0000, v74
    v_fmac_f32 v12, v3, v98
    v_fmac_f32 v13, v4, v98
    v_fmac_f32 v20, v3, v99
    v_fmac_f32 v21, v4, v99
    v_lshlrev_b32 v3, 16, v75
    v_and_b32 v4, 0xffff0000, v75
    v_fmac_f32 v14, v3, v98
    v_fmac_f32 v15, v4, v98
    v_fmac_f32 v22, v3, v99
    v_fmac_f32 v23, v4, v99
    s_waitcnt vmcnt(3)
    v_lshlrev_b32 v3, 16, v76
    v_and_b32 v4, 0xffff0000, v76
    v_fmac_f32 v8, v3, v100
    v_fmac_f32 v9, v4, v100
    v_fmac_f32 v16, v3, v101
    v_fmac_f32 v17, v4, v101
    v_lshlrev_b32 v3, 16, v77
    v_and_b32 v4, 0xffff0000, v77
    v_fmac_f32 v10, v3, v100
    v_fmac_f32 v11, v4, v100
    v_fmac_f32 v18, v3, v101
    v_fmac_f32 v19, v4, v101
    v_lshlrev_b32 v3, 16, v78
    v_and_b32 v4, 0xffff0000, v78
    v_fmac_f32 v12, v3, v100
    v_fmac_f32 v13, v4, v100
    v_fmac_f32 v20, v3, v101
    v_fmac_f32 v21, v4, v101
    v_lshlrev_b32 v3, 16, v79
    v_and_b32 v4, 0xffff0000, v79
    v_fmac_f32 v14, v3, v100
    v_fmac_f32 v15, v4, v100
    v_fmac_f32 v22, v3, v101
    v_fmac_f32 v23, v4, v101
    s_waitcnt vmcnt(2)
    v_lshlrev_b32 v3, 16, v80
    v_and_b32 v4, 0xffff0000, v80
    v_fmac_f32 v8, v3, v102
    v_fmac_f32 v9, v4, v102
    v_fmac_f32 v16, v3, v103
    v_fmac_f32 v17, v4, v103
    v_lshlrev_b32 v3, 16, v81
    v_and_b32 v4, 0xffff0000, v81
    v_fmac_f32 v10, v3, v102
    v_fmac_f32 v11, v4, v102
    v_fmac_f32 v18, v3, v103
    v_fmac_f32 v19, v4, v103
    v_lshlrev_b32 v3, 16, v82
    v_and_b32 v4, 0xffff0000, v82
    v_fmac_f32 v12, v3, v102
    v_fmac_f32 v13, v4, v102
    v_fmac_f32 v20, v3, v103
    v_fmac_f32 v21, v4, v103
    v_lshlrev_b32 v3, 16, v83
    v_and_b32 v4, 0xffff0000, v83
    v_fmac_f32 v14, v3, v102
    v_fmac_f32 v15, v4, v102
    v_fmac_f32 v22, v3, v103
    v_fmac_f32 v23, v4, v103
    s_waitcnt vmcnt(1)
    v_lshlrev_b32 v3, 16, v84
    v_and_b32 v4, 0xffff0000, v84
    v_fmac_f32 v8, v3, v104
    v_fmac_f32 v9, v4, v104
    v_fmac_f32 v16, v3, v105
    v_fmac_f32 v17, v4, v105
    v_lshlrev_b32 v3, 16, v85
    v_and_b32 v4, 0xffff0000, v85
    v_fmac_f32 v10, v3, v104
    v_fmac_f32 v11, v4, v104
    v_fmac_f32 v18, v3, v105
    v_fmac_f32 v19, v4, v105
    v_lshlrev_b32 v3, 16, v86
    v_and_b32 v4, 0xffff0000, v86
    v_fmac_f32 v12, v3, v104
    v_fmac_f32 v13, v4, v104
    v_fmac_f32 v20, v3, v105
    v_fmac_f32 v21, v4, v105
    v_lshlrev_b32 v3, 16, v87
    v_and_b32 v4, 0xffff0000, v87
    v_fmac_f32 v14, v3, v104
    v_fmac_f32 v15, v4, v104
    v_fmac_f32 v22, v3, v105
    v_fmac_f32 v23, v4, v105
    s_waitcnt vmcnt(0)
    v_lshlrev_b32 v3, 16, v88
    v_and_b32 v4, 0xffff0000, v88
    v_fmac_f32 v8, v3, v106
    v_fmac_f32 v9, v4, v106
    v_fmac_f32 v16, v3, v107
    v_fmac_f32 v17, v4, v107
    v_lshlrev_b32 v3, 16, v89
    v_and_b32 v4, 0xffff0000, v89
    v_fmac_f32 v10, v3, v106
    v_fmac_f32 v11, v4, v106
    v_fmac_f32 v18, v3, v107
    v_fmac_f32 v19, v4, v107
    v_lshlrev_b32 v3, 16, v90
    v_and_b32 v4, 0xffff0000, v90
    v_fmac_f32 v12, v3, v106
    v_fmac_f32 v13, v4, v106
    v_fmac_f32 v20, v3, v107
    v_fmac_f32 v21, v4, v107
    v_lshlrev_b32 v3, 16, v91
    v_and_b32 v4, 0xffff0000, v91
    v_fmac_f32 v14, v3, v106
    v_fmac_f32 v15, v4, v106
    v_fmac_f32 v22, v3, v107
    v_fmac_f32 v23, v4, v107
    v_lshlrev_b32 v2, 6, v0
    ds_write_b128 v2, v[8:11] offset:8192
    ds_write_b128 v2, v[12:15] offset:8208
    ds_write_b128 v2, v[16:19] offset:8224
    ds_write_b128 v2, v[20:23] offset:8240
    v_bfe_u32 v3, v1, 3, 2
    v_lshlrev_b32 v3, 6, v3
    v_lshrrev_b32 v4, 5, v1
    v_lshlrev_b32 v4, 5, v4
    v_add_u32 v3, v3, v4
    v_and_b32 v4, 7, v1
    v_lshlrev_b32 v4, 2, v4
    v_add_u32 v3, v3, v4
    s_lshl_b32 s37, s36, 12
    v_add_u32 v3, s37, v3
    s_waitcnt lgkmcnt(0)
    ds_read_b32 v60, v3 offset:8192
    ds_read_b32 v61, v3 offset:8448
    ds_read_b32 v62, v3 offset:8704
    ds_read_b32 v63, v3 offset:8960
    ds_read_b32 v64, v3 offset:9216
    ds_read_b32 v65, v3 offset:9472
    ds_read_b32 v66, v3 offset:9728
    ds_read_b32 v67, v3 offset:9984
    ds_read_b32 v68, v3 offset:10240
    ds_read_b32 v69, v3 offset:10496
    ds_read_b32 v70, v3 offset:10752
    ds_read_b32 v71, v3 offset:11008
    ds_read_b32 v72, v3 offset:11264
    ds_read_b32 v73, v3 offset:11520
    ds_read_b32 v74, v3 offset:11776
    ds_read_b32 v75, v3 offset:12032
    s_waitcnt lgkmcnt(0)
    v_add_f32 v60, v60, v61
    v_add_f32 v60, v60, v62
    v_add_f32 v60, v60, v63
    v_add_f32 v60, v60, v64
    v_add_f32 v60, v60, v65
    v_add_f32 v60, v60, v66
    v_add_f32 v60, v60, v67
    v_add_f32 v60, v60, v68
    v_add_f32 v60, v60, v69
    v_add_f32 v60, v60, v70
    v_add_f32 v60, v60, v71
    v_add_f32 v60, v60, v72
    v_add_f32 v60, v60, v73
    v_add_f32 v60, v60, v74
    v_add_f32 v60, v60, v75
    v_lshlrev_b32 v2, 2, v0
    ds_write_b32 v2, v60 offset:32768
    s_waitcnt lgkmcnt(0)
    s_barrier
    s_cmp_eq_u32 s36, 0
    s_cbranch_scc0 tail_end
    v_lshlrev_b32 v2, 2, v1
    ds_read_b32 v60, v2 offset:32768
    ds_read_b32 v61, v2 offset:33024
    ds_read_b32 v62, v2 offset:33280
    ds_read_b32 v63, v2 offset:33536
    ds_read_b32 v64, v2 offset:33792
    ds_read_b32 v65, v2 offset:34048
    v_lshrrev_b32 v2, 5, v1
    v_mul_u32_u24 v2, 2560, v2
    v_and_b32 v3, 31, v1
    v_lshlrev_b32 v3, 2, v3
    v_add_u32 v2, v2, v3
    s_mul_i32 s37, s24, 5120
    s_lshl_b32 s38, s25, 7
    s_add_u32 s37, s37, s38
    s_add_u32 s37, s37, 262144
    s_waitcnt lgkmcnt(0)
    v_add_f32 v60, v60, v61
    v_add_f32 v62, v62, v63
    v_add_f32 v64, v64, v65
    v_add_f32 v60, v60, v62
    v_add_f32 v60, v60, v64
    buffer_store_dword v60, v2, s[20:23], s37 offen sc1
    s_endpgm
tail_ffn:
    s_nop 4
    s_cmp_eq_u32 s36, 5
    s_cbranch_scc1 tail_end
    s_load_dwordx2 s[4:5], s[0:1], 0
    s_load_dwordx4 s[8:11], s[0:1], 48
    s_load_dwordx2 s[12:13], s[0:1], 64
    s_sub_u32 s40, s2, 160
    v_lshlrev_b32 v7, 4, v0
    s_waitcnt lgkmcnt(0)
    s_mov_b32 s16, s4
    s_and_b32 s17, s5, 0xffff
    s_mov_b32 s18, 2560
    s_mov_b32 s19, 0x00020000
    s_mov_b32 s20, s8
    s_and_b32 s21, s9, 0xffff
    s_mov_b32 s22, 1966080
    s_mov_b32 s23, 0x00020000
    s_mov_b32 s24, s10
    s_and_b32 s25, s11, 0xffff
    s_mov_b32 s26, 3072
    s_mov_b32 s27, 0x00020000
    s_mov_b32 s28, s12
    s_and_b32 s29, s13, 0xffff
    s_mov_b32 s30, 1966080
    s_mov_b32 s31, 0x00020000
    s_mov_b32 s32, s14
    s_and_b32 s33, s15, 0xffff
    s_mov_b32 s34, 1048576
    s_mov_b32 s35, 0x00020000
    v_lshlrev_b32 v3, 3, v0
    buffer_load_dwordx2 v[120:121], v3, s[16:19], 0 offen
    v_and_b32 v3, 31, v1
    v_lshlrev_b32 v3, 1, v3
    s_lshl_b32 s37, s40, 6
    buffer_load_ushort v122, v3, s[24:27], s37 offen
    v_lshrrev_b32 v2, 2, v1
    v_mul_u32_u24 v2, 3072, v2
    v_and_b32 v3, 3, v1
    v_lshlrev_b32 v3, 4, v3
    v_add_u32 v2, v2, v3
    s_mul_i32 s38, s36, 393216
    s_add_u32 s38, s38, s37
    s_add_u32 s39, s38, 0
    buffer_load_dwordx4 v[24:27], v2, s[20:23], s39 offen
    s_add_u32 s39, s38, 49152
    buffer_load_dwordx4 v[28:31], v2, s[20:23], s39 offen
    s_add_u32 s39, s38, 98304
    buffer_load_dwordx4 v[32:35], v2, s[20:23], s39 offen
    s_add_u32 s39, s38, 147456
    buffer_load_dwordx4 v[36:39], v2, s[20:23], s39 offen
    s_add_u32 s39, s38, 196608
    buffer_load_dwordx4 v[40:43], v2, s[20:23], s39 offen
    s_add_u32 s39, s38, 245760
    buffer_load_dwordx4 v[44:47], v2, s[20:23], s39 offen
    s_add_u32 s39, s38, 294912
    buffer_load_dwordx4 v[48:51], v2, s[20:23], s39 offen
    s_add_u32 s39, s38, 344064
    buffer_load_dwordx4 v[52:55], v2, s[20:23], s39 offen
    v_mul_u32_u24 v5, 52429, v0
    v_lshrrev_b32 v5, 22, v5
    v_mul_u32_u24 v2, 80, v5
    v_sub_u32 v6, v0, v2
    v_mul_u32_u24 v2, 10240, v5
    v_lshlrev_b32 v3, 4, v6
    v_add_u32 v2, v2, v3
    s_mul_i32 s38, s40, 40960
    s_add_u32 s39, s38, 0
    buffer_load_dwordx4 v[56:59], v2, s[28:31], s39 offen
    s_add_u32 s39, s38, 1280
    buffer_load_dwordx4 v[60:63], v2, s[28:31], s39 offen
    s_add_u32 s39, s38, 2560
    buffer_load_dwordx4 v[64:67], v2, s[28:31], s39 offen
    s_add_u32 s39, s38, 3840
    buffer_load_dwordx4 v[68:71], v2, s[28:31], s39 offen
    s_add_u32 s39, s38, 5120
    buffer_load_dwordx4 v[72:75], v2, s[28:31], s39 offen
    s_add_u32 s39, s38, 6400
    buffer_load_dwordx4 v[76:79], v2, s[28:31], s39 offen
    s_add_u32 s39, s38, 7680
    buffer_load_dwordx4 v[80:83], v2, s[28:31], s39 offen
    s_add_u32 s39, s38, 8960
    buffer_load_dwordx4 v[84:87], v2, s[28:31], s39 offen
    v_cmp_le_u32 vcc, 160, v0
    s_mov_b64 s[42:43], vcc
    v_cndmask_b32 v138, 0, 1, s[42:43]
    v_lshrrev_b32 v2, 5, v0
    v_mul_u32_u24 v3, 3, v138
    v_add_u32 v2, v2, v3
    v_lshlrev_b32 v139, 2, v2
    v_lshlrev_b32 v140, 5, v138
    v_mul_u32_u24 v4, 160, v138
    v_sub_u32 v4, v0, v4
    v_lshlrev_b32 v4, 5, v4
    v_lshlrev_b32 v3, 2, v138
    v_add_u32 v141, v4, v3
ffn_poll:
    s_nop 4
    s_mov_b32 s39, 262144
    buffer_load_dwordx4 v[88:91], v7, s[32:35], s39 offen sc1
    s_mov_b32 s39, 267264
    buffer_load_dwordx4 v[92:95], v7, s[32:35], s39 offen sc1
    s_mov_b32 s39, 272384
    buffer_load_dwordx4 v[96:99], v7, s[32:35], s39 offen sc1
    s_mov_b32 s39, 277504
    buffer_load_dwordx4 v[100:103], v7, s[32:35], s39 offen sc1
    s_mov_b32 s39, 282624
    buffer_load_dwordx4 v[104:107], v7, s[32:35], s39 offen sc1
    s_mov_b32 s39, 287744
    buffer_load_dwordx4 v[108:111], v7, s[32:35], s39 offen sc1
    s_mov_b32 s39, 292864
    buffer_load_dwordx4 v[112:115], v7, s[32:35], s39 offen sc1
    s_mov_b32 s39, 297984
    buffer_load_dwordx4 v[116:119], v7, s[32:35], s39 offen sc1
    s_waitcnt vmcnt(0)
    v_max3_u32 v2, v88, v89, v90
    v_max3_u32 v2, v2, v91, v92
    v_max3_u32 v2, v2, v93, v94
    v_max3_u32 v2, v2, v95, v96
    v_max3_u32 v2, v2, v97, v98
    v_max3_u32 v2, v2, v99, v100
    v_max3_u32 v2, v2, v101, v102
    v_max3_u32 v2, v2, v103, v104
    v_max3_u32 v2, v2, v105, v106
    v_max3_u32 v2, v2, v107, v108
    v_max3_u32 v2, v2, v109, v110
    v_max3_u32 v2, v2, v111, v112
    v_max3_u32 v2, v2, v113, v114
    v_max3_u32 v2, v2, v115, v116
    v_max3_u32 v2, v2, v117, v118
    v_max_u32 v2, v2, v119
    v_cmp_eq_u32 vcc, -1, v2
    s_cbranch_vccz ffn_poll_done
    s_sleep 2
    s_branch ffn_poll
ffn_poll_done:
    s_nop 4
    v_add_f32 v124, v88, v92
    v_add_f32 v2, v96, v100
    v_add_f32 v3, v104, v108
    v_add_f32 v4, v112, v116
    v_add_f32 v124, v124, v2
    v_add_f32 v3, v3, v4
    v_add_f32 v124, v124, v3
    v_add_f32 v125, v89, v93
    v_add_f32 v2, v97, v101
    v_add_f32 v3, v105, v109
    v_add_f32 v4, v113, v117
    v_add_f32 v125, v125, v2
    v_add_f32 v3, v3, v4
    v_add_f32 v125, v125, v3
    v_add_f32 v126, v90, v94
    v_add_f32 v2, v98, v102
    v_add_f32 v3, v106, v110
    v_add_f32 v4, v114, v118
    v_add_f32 v126, v126, v2
    v_add_f32 v3, v3, v4
    v_add_f32 v126, v126, v3
    v_add_f32 v127, v91, v95
    v_add_f32 v2, v99, v103
    v_add_f32 v3, v107, v111
    v_add_f32 v4, v115, v119
    v_add_f32 v127, v127, v2
    v_add_f32 v3, v3, v4
    v_add_f32 v127, v127, v3
    v_cvt_pk_bf16_f32 v2, v124, v125
    v_lshlrev_b32 v124, 16, v2
    v_and_b32 v125, 0xffff0000, v2
    v_cvt_pk_bf16_f32 v2, v126, v127
    v_lshlrev_b32 v126, 16, v2
    v_and_b32 v127, 0xffff0000, v2
    v_lshlrev_b32 v2, 16, v120
    v_add_f32 v124, v124, v2
    v_and_b32 v2, 0xffff0000, v120
    v_add_f32 v125, v125, v2
    v_lshlrev_b32 v2, 16, v121
    v_add_f32 v126, v126, v2
    v_and_b32 v2, 0xffff0000, v121
    v_add_f32 v127, v127, v2
    v_cvt_pk_bf16_f32 v2, v124, v125
    v_lshlrev_b32 v124, 16, v2
    v_and_b32 v125, 0xffff0000, v2
    v_cvt_pk_bf16_f32 v2, v126, v127
    v_lshlrev_b32 v126, 16, v2
    v_and_b32 v127, 0xffff0000, v2
    s_cmp_eq_u32 s40, 0
    s_cbranch_scc0 ffn_nohh
    s_mov_b32 s39, 548864
    buffer_store_dwordx4 v[124:127], v7, s[32:35], s39 offen sc1
ffn_nohh:
    s_nop 4
    v_add_f32 v2, v124, v125
    v_add_f32 v3, v126, v127
    v_add_f32 v2, v2, v3
    s_nop 1
    v_add_f32_dpp v2, v2, v2 quad_perm:[1,0,3,2] row_mask:0xf bank_mask:0xf
    s_nop 1
    v_add_f32_dpp v2, v2, v2 quad_perm:[2,3,0,1] row_mask:0xf bank_mask:0xf
    s_nop 1
    v_add_f32_dpp v2, v2, v2 row_half_mirror row_mask:0xf bank_mask:0xf
    s_nop 1
    v_add_f32_dpp v2, v2, v2 row_mirror row_mask:0xf bank_mask:0xf
    v_mov_b32 v3, v2
    s_nop 1
    v_permlane16_swap_b32 v2, v3
    v_add_f32 v2, v2, v3
    ds_write_b32 v139, v2 offset:0
    s_waitcnt lgkmcnt(0)
    s_barrier
    ds_read_b128 v[128:131], v140 offset:0
    ds_read_b32 v132, v140 offset:16
    s_waitcnt lgkmcnt(0)
    v_add_f32 v128, v128, v129
    v_add_f32 v130, v130, v131
    v_add_f32 v128, v128, v132
    v_add_f32 v128, v128, v130
    v_mul_f32 v133, 0x3acccccd, v128
    v_sub_f32 v3, v124, v133
    v_mul_f32 v2, v3, v3
    v_sub_f32 v3, v125, v133
    v_fmac_f32 v2, v3, v3
    v_sub_f32 v3, v126, v133
    v_fmac_f32 v2, v3, v3
    v_sub_f32 v3, v127, v133
    v_fmac_f32 v2, v3, v3
    s_nop 1
    v_add_f32_dpp v2, v2, v2 quad_perm:[1,0,3,2] row_mask:0xf bank_mask:0xf
    s_nop 1
    v_add_f32_dpp v2, v2, v2 quad_perm:[2,3,0,1] row_mask:0xf bank_mask:0xf
    s_nop 1
    v_add_f32_dpp v2, v2, v2 row_half_mirror row_mask:0xf bank_mask:0xf
    s_nop 1
    v_add_f32_dpp v2, v2, v2 row_mirror row_mask:0xf bank_mask:0xf
    v_mov_b32 v3, v2
    s_nop 1
    v_permlane16_swap_b32 v2, v3
    v_add_f32 v2, v2, v3
    ds_write_b32 v139, v2 offset:64
    v_cvt_pk_bf16_f32 v136, v133, v133
    v_lshlrev_b32 v136, 16, v136
    s_waitcnt lgkmcnt(0)
    s_barrier
    ds_read_b128 v[128:131], v140 offset:64
    ds_read_b32 v132, v140 offset:80
    v_sub_f32 v124, v124, v136
    v_sub_f32 v125, v125, v136
    v_sub_f32 v126, v126, v136
    v_sub_f32 v127, v127, v136
    v_cvt_pk_bf16_f32 v2, v124, v125
    v_lshlrev_b32 v124, 16, v2
    v_and_b32 v125, 0xffff0000, v2
    v_cvt_pk_bf16_f32 v2, v126, v127
    v_lshlrev_b32 v126, 16, v2
    v_and_b32 v127, 0xffff0000, v2
    s_waitcnt lgkmcnt(0)
    v_add_f32 v128, v128, v129
    v_add_f32 v130, v130, v131
    v_add_f32 v128, v128, v132
    v_add_f32 v128, v128, v130
    v_mul_f32 v128, 0x3acccccd, v128
    v_cvt_pk_bf16_f32 v128, v128, v128
    v_lshlrev_b32 v128, 16, v128
    v_add_f32 v128, 0x3727c5ac, v128
    v_cvt_pk_bf16_f32 v128, v128, v128
    v_lshlrev_b32 v128, 16, v128
    v_sqrt_f32 v128, v128
    s_nop 0
    v_cvt_pk_bf16_f32 v137, v128, v128
    v_lshlrev_b32 v137, 16, v137
    v_rcp_f32 v129, v137
    s_nop 0
    v_mul_f32 v130, v124, v129
    v_fma_f32 v124, -v130, v137, v124
    v_fma_f32 v124, v124, v129, v130
    v_mul_f32 v130, v125, v129
    v_fma_f32 v125, -v130, v137, v125
    v_fma_f32 v125, v125, v129, v130
    v_mul_f32 v130, v126, v129
    v_fma_f32 v126, -v130, v137, v126
    v_fma_f32 v126, v126, v129, v130
    v_mul_f32 v130, v127, v129
    v_fma_f32 v127, -v130, v137, v127
    v_fma_f32 v127, v127, v129, v130
    v_cvt_pk_bf16_f32 v2, v124, v125
    v_lshlrev_b32 v124, 16, v2
    v_and_b32 v125, 0xffff0000, v2
    v_cvt_pk_bf16_f32 v2, v126, v127
    v_lshlrev_b32 v126, 16, v2
    v_and_b32 v127, 0xffff0000, v2
    ds_write_b32 v141, v124 offset:5120
    ds_write_b32 v141, v125 offset:5128
    ds_write_b32 v141, v126 offset:5136
    ds_write_b32 v141, v127 offset:5144
    v_lshrrev_b32 v2, 2, v1
    s_lshl_b32 s37, s36, 7
    v_add_u32 v2, s37, v2
    v_lshlrev_b32 v2, 3, v2
    v_mov_b32 v8, 0
    v_mov_b32 v9, 0
    v_mov_b32 v10, 0
    v_mov_b32 v11, 0
    v_mov_b32 v12, 0
    v_mov_b32 v13, 0
    v_mov_b32 v14, 0
    v_mov_b32 v15, 0
    v_mov_b32 v16, 0
    v_mov_b32 v17, 0
    v_mov_b32 v18, 0
    v_mov_b32 v19, 0
    v_mov_b32 v20, 0
    v_mov_b32 v21, 0
    v_mov_b32 v22, 0
    v_mov_b32 v23, 0
    s_waitcnt lgkmcnt(0)
    s_barrier
    ds_read_b64 v[88:89], v2 offset:5120
    ds_read_b64 v[90:91], v2 offset:5248
    ds_read_b64 v[92:93], v2 offset:5376
    ds_read_b64 v[94:95], v2 offset:5504
    ds_read_b64 v[96:97], v2 offset:5632
    ds_read_b64 v[98:99], v2 offset:5760
    ds_read_b64 v[100:101], v2 offset:5888
    ds_read_b64 v[102:103], v2 offset:6016
    s_waitcnt lgkmcnt(7)
    v_lshlrev_b32 v3, 16, v24
    v_and_b32 v4, 0xffff0000, v24
    v_fmac_f32 v8, v3, v88
    v_fmac_f32 v9, v4, v88
    v_fmac_f32 v16, v3, v89
    v_fmac_f32 v17, v4, v89
    v_lshlrev_b32 v3, 16, v25
    v_and_b32 v4, 0xffff0000, v25
    v_fmac_f32 v10, v3, v88
    v_fmac_f32 v11, v4, v88
    v_fmac_f32 v18, v3, v89
    v_fmac_f32 v19, v4, v89
    v_lshlrev_b32 v3, 16, v26
    v_and_b32 v4, 0xffff0000, v26
    v_fmac_f32 v12, v3, v88
    v_fmac_f32 v13, v4, v88
    v_fmac_f32 v20, v3, v89
    v_fmac_f32 v21, v4, v89
    v_lshlrev_b32 v3, 16, v27
    v_and_b32 v4, 0xffff0000, v27
    v_fmac_f32 v14, v3, v88
    v_fmac_f32 v15, v4, v88
    v_fmac_f32 v22, v3, v89
    v_fmac_f32 v23, v4, v89
    s_waitcnt lgkmcnt(6)
    v_lshlrev_b32 v3, 16, v28
    v_and_b32 v4, 0xffff0000, v28
    v_fmac_f32 v8, v3, v90
    v_fmac_f32 v9, v4, v90
    v_fmac_f32 v16, v3, v91
    v_fmac_f32 v17, v4, v91
    v_lshlrev_b32 v3, 16, v29
    v_and_b32 v4, 0xffff0000, v29
    v_fmac_f32 v10, v3, v90
    v_fmac_f32 v11, v4, v90
    v_fmac_f32 v18, v3, v91
    v_fmac_f32 v19, v4, v91
    v_lshlrev_b32 v3, 16, v30
    v_and_b32 v4, 0xffff0000, v30
    v_fmac_f32 v12, v3, v90
    v_fmac_f32 v13, v4, v90
    v_fmac_f32 v20, v3, v91
    v_fmac_f32 v21, v4, v91
    v_lshlrev_b32 v3, 16, v31
    v_and_b32 v4, 0xffff0000, v31
    v_fmac_f32 v14, v3, v90
    v_fmac_f32 v15, v4, v90
    v_fmac_f32 v22, v3, v91
    v_fmac_f32 v23, v4, v91
    s_waitcnt lgkmcnt(5)
    v_lshlrev_b32 v3, 16, v32
    v_and_b32 v4, 0xffff0000, v32
    v_fmac_f32 v8, v3, v92
    v_fmac_f32 v9, v4, v92
    v_fmac_f32 v16, v3, v93
    v_fmac_f32 v17, v4, v93
    v_lshlrev_b32 v3, 16, v33
    v_and_b32 v4, 0xffff0000, v33
    v_fmac_f32 v10, v3, v92
    v_fmac_f32 v11, v4, v92
    v_fmac_f32 v18, v3, v93
    v_fmac_f32 v19, v4, v93
    v_lshlrev_b32 v3, 16, v34
    v_and_b32 v4, 0xffff0000, v34
    v_fmac_f32 v12, v3, v92
    v_fmac_f32 v13, v4, v92
    v_fmac_f32 v20, v3, v93
    v_fmac_f32 v21, v4, v93
    v_lshlrev_b32 v3, 16, v35
    v_and_b32 v4, 0xffff0000, v35
    v_fmac_f32 v14, v3, v92
    v_fmac_f32 v15, v4, v92
    v_fmac_f32 v22, v3, v93
    v_fmac_f32 v23, v4, v93
    s_waitcnt lgkmcnt(4)
    v_lshlrev_b32 v3, 16, v36
    v_and_b32 v4, 0xffff0000, v36
    v_fmac_f32 v8, v3, v94
    v_fmac_f32 v9, v4, v94
    v_fmac_f32 v16, v3, v95
    v_fmac_f32 v17, v4, v95
    v_lshlrev_b32 v3, 16, v37
    v_and_b32 v4, 0xffff0000, v37
    v_fmac_f32 v10, v3, v94
    v_fmac_f32 v11, v4, v94
    v_fmac_f32 v18, v3, v95
    v_fmac_f32 v19, v4, v95
    v_lshlrev_b32 v3, 16, v38
    v_and_b32 v4, 0xffff0000, v38
    v_fmac_f32 v12, v3, v94
    v_fmac_f32 v13, v4, v94
    v_fmac_f32 v20, v3, v95
    v_fmac_f32 v21, v4, v95
    v_lshlrev_b32 v3, 16, v39
    v_and_b32 v4, 0xffff0000, v39
    v_fmac_f32 v14, v3, v94
    v_fmac_f32 v15, v4, v94
    v_fmac_f32 v22, v3, v95
    v_fmac_f32 v23, v4, v95
    s_waitcnt lgkmcnt(3)
    v_lshlrev_b32 v3, 16, v40
    v_and_b32 v4, 0xffff0000, v40
    v_fmac_f32 v8, v3, v96
    v_fmac_f32 v9, v4, v96
    v_fmac_f32 v16, v3, v97
    v_fmac_f32 v17, v4, v97
    v_lshlrev_b32 v3, 16, v41
    v_and_b32 v4, 0xffff0000, v41
    v_fmac_f32 v10, v3, v96
    v_fmac_f32 v11, v4, v96
    v_fmac_f32 v18, v3, v97
    v_fmac_f32 v19, v4, v97
    v_lshlrev_b32 v3, 16, v42
    v_and_b32 v4, 0xffff0000, v42
    v_fmac_f32 v12, v3, v96
    v_fmac_f32 v13, v4, v96
    v_fmac_f32 v20, v3, v97
    v_fmac_f32 v21, v4, v97
    v_lshlrev_b32 v3, 16, v43
    v_and_b32 v4, 0xffff0000, v43
    v_fmac_f32 v14, v3, v96
    v_fmac_f32 v15, v4, v96
    v_fmac_f32 v22, v3, v97
    v_fmac_f32 v23, v4, v97
    s_waitcnt lgkmcnt(2)
    v_lshlrev_b32 v3, 16, v44
    v_and_b32 v4, 0xffff0000, v44
    v_fmac_f32 v8, v3, v98
    v_fmac_f32 v9, v4, v98
    v_fmac_f32 v16, v3, v99
    v_fmac_f32 v17, v4, v99
    v_lshlrev_b32 v3, 16, v45
    v_and_b32 v4, 0xffff0000, v45
    v_fmac_f32 v10, v3, v98
    v_fmac_f32 v11, v4, v98
    v_fmac_f32 v18, v3, v99
    v_fmac_f32 v19, v4, v99
    v_lshlrev_b32 v3, 16, v46
    v_and_b32 v4, 0xffff0000, v46
    v_fmac_f32 v12, v3, v98
    v_fmac_f32 v13, v4, v98
    v_fmac_f32 v20, v3, v99
    v_fmac_f32 v21, v4, v99
    v_lshlrev_b32 v3, 16, v47
    v_and_b32 v4, 0xffff0000, v47
    v_fmac_f32 v14, v3, v98
    v_fmac_f32 v15, v4, v98
    v_fmac_f32 v22, v3, v99
    v_fmac_f32 v23, v4, v99
    s_waitcnt lgkmcnt(1)
    v_lshlrev_b32 v3, 16, v48
    v_and_b32 v4, 0xffff0000, v48
    v_fmac_f32 v8, v3, v100
    v_fmac_f32 v9, v4, v100
    v_fmac_f32 v16, v3, v101
    v_fmac_f32 v17, v4, v101
    v_lshlrev_b32 v3, 16, v49
    v_and_b32 v4, 0xffff0000, v49
    v_fmac_f32 v10, v3, v100
    v_fmac_f32 v11, v4, v100
    v_fmac_f32 v18, v3, v101
    v_fmac_f32 v19, v4, v101
    v_lshlrev_b32 v3, 16, v50
    v_and_b32 v4, 0xffff0000, v50
    v_fmac_f32 v12, v3, v100
    v_fmac_f32 v13, v4, v100
    v_fmac_f32 v20, v3, v101
    v_fmac_f32 v21, v4, v101
    v_lshlrev_b32 v3, 16, v51
    v_and_b32 v4, 0xffff0000, v51
    v_fmac_f32 v14, v3, v100
    v_fmac_f32 v15, v4, v100
    v_fmac_f32 v22, v3, v101
    v_fmac_f32 v23, v4, v101
    s_waitcnt lgkmcnt(0)
    v_lshlrev_b32 v3, 16, v52
    v_and_b32 v4, 0xffff0000, v52
    v_fmac_f32 v8, v3, v102
    v_fmac_f32 v9, v4, v102
    v_fmac_f32 v16, v3, v103
    v_fmac_f32 v17, v4, v103
    v_lshlrev_b32 v3, 16, v53
    v_and_b32 v4, 0xffff0000, v53
    v_fmac_f32 v10, v3, v102
    v_fmac_f32 v11, v4, v102
    v_fmac_f32 v18, v3, v103
    v_fmac_f32 v19, v4, v103
    v_lshlrev_b32 v3, 16, v54
    v_and_b32 v4, 0xffff0000, v54
    v_fmac_f32 v12, v3, v102
    v_fmac_f32 v13, v4, v102
    v_fmac_f32 v20, v3, v103
    v_fmac_f32 v21, v4, v103
    v_lshlrev_b32 v3, 16, v55
    v_and_b32 v4, 0xffff0000, v55
    v_fmac_f32 v14, v3, v102
    v_fmac_f32 v15, v4, v102
    v_fmac_f32 v22, v3, v103
    v_fmac_f32 v23, v4, v103
    v_lshlrev_b32 v2, 6, v0
    ds_write_b128 v2, v[8:11] offset:10240
    ds_write_b128 v2, v[12:15] offset:10256
    ds_write_b128 v2, v[16:19] offset:10272
    ds_write_b128 v2, v[20:23] offset:10288
    v_bfe_u32 v3, v1, 3, 2
    v_lshlrev_b32 v3, 6, v3
    v_lshrrev_b32 v4, 5, v1
    v_lshlrev_b32 v4, 5, v4
    v_add_u32 v3, v3, v4
    v_and_b32 v4, 7, v1
    v_lshlrev_b32 v4, 2, v4
    v_add_u32 v3, v3, v4
    s_lshl_b32 s37, s36, 12
    v_add_u32 v3, s37, v3
    s_waitcnt lgkmcnt(0)
    ds_read_b32 v24, v3 offset:10240
    ds_read_b32 v25, v3 offset:10496
    ds_read_b32 v26, v3 offset:10752
    ds_read_b32 v27, v3 offset:11008
    ds_read_b32 v28, v3 offset:11264
    ds_read_b32 v29, v3 offset:11520
    ds_read_b32 v30, v3 offset:11776
    ds_read_b32 v31, v3 offset:12032
    ds_read_b32 v32, v3 offset:12288
    ds_read_b32 v33, v3 offset:12544
    ds_read_b32 v34, v3 offset:12800
    ds_read_b32 v35, v3 offset:13056
    ds_read_b32 v36, v3 offset:13312
    ds_read_b32 v37, v3 offset:13568
    ds_read_b32 v38, v3 offset:13824
    ds_read_b32 v39, v3 offset:14080
    s_waitcnt lgkmcnt(0)
    v_add_f32 v24, v24, v25
    v_add_f32 v24, v24, v26
    v_add_f32 v24, v24, v27
    v_add_f32 v24, v24, v28
    v_add_f32 v24, v24, v29
    v_add_f32 v24, v24, v30
    v_add_f32 v24, v24, v31
    v_add_f32 v24, v24, v32
    v_add_f32 v24, v24, v33
    v_add_f32 v24, v24, v34
    v_add_f32 v24, v24, v35
    v_add_f32 v24, v24, v36
    v_add_f32 v24, v24, v37
    v_add_f32 v24, v24, v38
    v_add_f32 v24, v24, v39
    v_lshlrev_b32 v2, 2, v0
    ds_write_b32 v2, v24 offset:30720
    s_waitcnt lgkmcnt(0)
    s_barrier
    s_cmp_eq_u32 s36, 0
    s_cbranch_scc0 ffn_h1_skip
    v_lshlrev_b32 v2, 2, v1
    ds_read_b32 v24, v2 offset:30720
    ds_read_b32 v25, v2 offset:30976
    ds_read_b32 v26, v2 offset:31232
    ds_read_b32 v27, v2 offset:31488
    ds_read_b32 v28, v2 offset:31744
    v_lshlrev_b32 v122, 16, v122
    v_and_b32 v2, 31, v1
    v_lshlrev_b32 v2, 3, v2
    v_lshrrev_b32 v3, 5, v1
    v_lshlrev_b32 v3, 2, v3
    v_add_u32 v2, v2, v3
    s_waitcnt lgkmcnt(0)
    v_add_f32 v24, v24, v25
    v_add_f32 v26, v26, v27
    v_add_f32 v24, v24, v28
    v_add_f32 v24, v24, v26
    v_cvt_pk_bf16_f32 v24, v24, v24
    v_lshlrev_b32 v24, 16, v24
    v_add_f32 v24, v24, v122
    v_cvt_pk_bf16_f32 v24, v24, v24
    v_lshlrev_b32 v24, 16, v24
    v_max_f32 v24, 0, v24
    v_mul_f32 v24, v24, v24
    v_cvt_pk_bf16_f32 v24, v24, v24
    v_lshlrev_b32 v24, 16, v24
    ds_write_b32 v2, v24 offset:32000
    s_waitcnt lgkmcnt(0)
ffn_h1_skip:
    s_nop 4
    v_lshlrev_b32 v2, 6, v5
    v_mov_b32 v8, 0
    v_mov_b32 v9, 0
    v_mov_b32 v10, 0
    v_mov_b32 v11, 0
    v_mov_b32 v12, 0
    v_mov_b32 v13, 0
    v_mov_b32 v14, 0
    v_mov_b32 v15, 0
    v_mov_b32 v16, 0
    v_mov_b32 v17, 0
    v_mov_b32 v18, 0
    v_mov_b32 v19, 0
    v_mov_b32 v20, 0
    v_mov_b32 v21, 0
    v_mov_b32 v22, 0
    v_mov_b32 v23, 0
    s_barrier
    ds_read_b128 v[88:91], v2 offset:32000
    ds_read_b128 v[92:95], v2 offset:32016
    ds_read_b128 v[96:99], v2 offset:32032
    ds_read_b128 v[100:103], v2 offset:32048
    s_waitcnt lgkmcnt(0)
    v_lshlrev_b32 v3, 16, v56
    v_and_b32 v4, 0xffff0000, v56
    v_fmac_f32 v8, v3, v88
    v_fmac_f32 v9, v4, v88
    v_fmac_f32 v16, v3, v89
    v_fmac_f32 v17, v4, v89
    v_lshlrev_b32 v3, 16, v57
    v_and_b32 v4, 0xffff0000, v57
    v_fmac_f32 v10, v3, v88
    v_fmac_f32 v11, v4, v88
    v_fmac_f32 v18, v3, v89
    v_fmac_f32 v19, v4, v89
    v_lshlrev_b32 v3, 16, v58
    v_and_b32 v4, 0xffff0000, v58
    v_fmac_f32 v12, v3, v88
    v_fmac_f32 v13, v4, v88
    v_fmac_f32 v20, v3, v89
    v_fmac_f32 v21, v4, v89
    v_lshlrev_b32 v3, 16, v59
    v_and_b32 v4, 0xffff0000, v59
    v_fmac_f32 v14, v3, v88
    v_fmac_f32 v15, v4, v88
    v_fmac_f32 v22, v3, v89
    v_fmac_f32 v23, v4, v89
    v_lshlrev_b32 v3, 16, v60
    v_and_b32 v4, 0xffff0000, v60
    v_fmac_f32 v8, v3, v90
    v_fmac_f32 v9, v4, v90
    v_fmac_f32 v16, v3, v91
    v_fmac_f32 v17, v4, v91
    v_lshlrev_b32 v3, 16, v61
    v_and_b32 v4, 0xffff0000, v61
    v_fmac_f32 v10, v3, v90
    v_fmac_f32 v11, v4, v90
    v_fmac_f32 v18, v3, v91
    v_fmac_f32 v19, v4, v91
    v_lshlrev_b32 v3, 16, v62
    v_and_b32 v4, 0xffff0000, v62
    v_fmac_f32 v12, v3, v90
    v_fmac_f32 v13, v4, v90
    v_fmac_f32 v20, v3, v91
    v_fmac_f32 v21, v4, v91
    v_lshlrev_b32 v3, 16, v63
    v_and_b32 v4, 0xffff0000, v63
    v_fmac_f32 v14, v3, v90
    v_fmac_f32 v15, v4, v90
    v_fmac_f32 v22, v3, v91
    v_fmac_f32 v23, v4, v91
    v_lshlrev_b32 v3, 16, v64
    v_and_b32 v4, 0xffff0000, v64
    v_fmac_f32 v8, v3, v92
    v_fmac_f32 v9, v4, v92
    v_fmac_f32 v16, v3, v93
    v_fmac_f32 v17, v4, v93
    v_lshlrev_b32 v3, 16, v65
    v_and_b32 v4, 0xffff0000, v65
    v_fmac_f32 v10, v3, v92
    v_fmac_f32 v11, v4, v92
    v_fmac_f32 v18, v3, v93
    v_fmac_f32 v19, v4, v93
    v_lshlrev_b32 v3, 16, v66
    v_and_b32 v4, 0xffff0000, v66
    v_fmac_f32 v12, v3, v92
    v_fmac_f32 v13, v4, v92
    v_fmac_f32 v20, v3, v93
    v_fmac_f32 v21, v4, v93
    v_lshlrev_b32 v3, 16, v67
    v_and_b32 v4, 0xffff0000, v67
    v_fmac_f32 v14, v3, v92
    v_fmac_f32 v15, v4, v92
    v_fmac_f32 v22, v3, v93
    v_fmac_f32 v23, v4, v93
    v_lshlrev_b32 v3, 16, v68
    v_and_b32 v4, 0xffff0000, v68
    v_fmac_f32 v8, v3, v94
    v_fmac_f32 v9, v4, v94
    v_fmac_f32 v16, v3, v95
    v_fmac_f32 v17, v4, v95
    v_lshlrev_b32 v3, 16, v69
    v_and_b32 v4, 0xffff0000, v69
    v_fmac_f32 v10, v3, v94
    v_fmac_f32 v11, v4, v94
    v_fmac_f32 v18, v3, v95
    v_fmac_f32 v19, v4, v95
    v_lshlrev_b32 v3, 16, v70
    v_and_b32 v4, 0xffff0000, v70
    v_fmac_f32 v12, v3, v94
    v_fmac_f32 v13, v4, v94
    v_fmac_f32 v20, v3, v95
    v_fmac_f32 v21, v4, v95
    v_lshlrev_b32 v3, 16, v71
    v_and_b32 v4, 0xffff0000, v71
    v_fmac_f32 v14, v3, v94
    v_fmac_f32 v15, v4, v94
    v_fmac_f32 v22, v3, v95
    v_fmac_f32 v23, v4, v95
    v_lshlrev_b32 v3, 16, v72
    v_and_b32 v4, 0xffff0000, v72
    v_fmac_f32 v8, v3, v96
    v_fmac_f32 v9, v4, v96
    v_fmac_f32 v16, v3, v97
    v_fmac_f32 v17, v4, v97
    v_lshlrev_b32 v3, 16, v73
    v_and_b32 v4, 0xffff0000, v73
    v_fmac_f32 v10, v3, v96
    v_fmac_f32 v11, v4, v96
    v_fmac_f32 v18, v3, v97
    v_fmac_f32 v19, v4, v97
    v_lshlrev_b32 v3, 16, v74
    v_and_b32 v4, 0xffff0000, v74
    v_fmac_f32 v12, v3, v96
    v_fmac_f32 v13, v4, v96
    v_fmac_f32 v20, v3, v97
    v_fmac_f32 v21, v4, v97
    v_lshlrev_b32 v3, 16, v75
    v_and_b32 v4, 0xffff0000, v75
    v_fmac_f32 v14, v3, v96
    v_fmac_f32 v15, v4, v96
    v_fmac_f32 v22, v3, v97
    v_fmac_f32 v23, v4, v97
    v_lshlrev_b32 v3, 16, v76
    v_and_b32 v4, 0xffff0000, v76
    v_fmac_f32 v8, v3, v98
    v_fmac_f32 v9, v4, v98
    v_fmac_f32 v16, v3, v99
    v_fmac_f32 v17, v4, v99
    v_lshlrev_b32 v3, 16, v77
    v_and_b32 v4, 0xffff0000, v77
    v_fmac_f32 v10, v3, v98
    v_fmac_f32 v11, v4, v98
    v_fmac_f32 v18, v3, v99
    v_fmac_f32 v19, v4, v99
    v_lshlrev_b32 v3, 16, v78
    v_and_b32 v4, 0xffff0000, v78
    v_fmac_f32 v12, v3, v98
    v_fmac_f32 v13, v4, v98
    v_fmac_f32 v20, v3, v99
    v_fmac_f32 v21, v4, v99
    v_lshlrev_b32 v3, 16, v79
    v_and_b32 v4, 0xffff0000, v79
    v_fmac_f32 v14, v3, v98
    v_fmac_f32 v15, v4, v98
    v_fmac_f32 v22, v3, v99
    v_fmac_f32 v23, v4, v99
    v_lshlrev_b32 v3, 16, v80
    v_and_b32 v4, 0xffff0000, v80
    v_fmac_f32 v8, v3, v100
    v_fmac_f32 v9, v4, v100
    v_fmac_f32 v16, v3, v101
    v_fmac_f32 v17, v4, v101
    v_lshlrev_b32 v3, 16, v81
    v_and_b32 v4, 0xffff0000, v81
    v_fmac_f32 v10, v3, v100
    v_fmac_f32 v11, v4, v100
    v_fmac_f32 v18, v3, v101
    v_fmac_f32 v19, v4, v101
    v_lshlrev_b32 v3, 16, v82
    v_and_b32 v4, 0xffff0000, v82
    v_fmac_f32 v12, v3, v100
    v_fmac_f32 v13, v4, v100
    v_fmac_f32 v20, v3, v101
    v_fmac_f32 v21, v4, v101
    v_lshlrev_b32 v3, 16, v83
    v_and_b32 v4, 0xffff0000, v83
    v_fmac_f32 v14, v3, v100
    v_fmac_f32 v15, v4, v100
    v_fmac_f32 v22, v3, v101
    v_fmac_f32 v23, v4, v101
    v_lshlrev_b32 v3, 16, v84
    v_and_b32 v4, 0xffff0000, v84
    v_fmac_f32 v8, v3, v102
    v_fmac_f32 v9, v4, v102
    v_fmac_f32 v16, v3, v103
    v_fmac_f32 v17, v4, v103
    v_lshlrev_b32 v3, 16, v85
    v_and_b32 v4, 0xffff0000, v85
    v_fmac_f32 v10, v3, v102
    v_fmac_f32 v11, v4, v102
    v_fmac_f32 v18, v3, v103
    v_fmac_f32 v19, v4, v103
    v_lshlrev_b32 v3, 16, v86
    v_and_b32 v4, 0xffff0000, v86
    v_fmac_f32 v12, v3, v102
    v_fmac_f32 v13, v4, v102
    v_fmac_f32 v20, v3, v103
    v_fmac_f32 v21, v4, v103
    v_lshlrev_b32 v3, 16, v87
    v_and_b32 v4, 0xffff0000, v87
    v_fmac_f32 v14, v3, v102
    v_fmac_f32 v15, v4, v102
    v_fmac_f32 v22, v3, v103
    v_fmac_f32 v23, v4, v103
    v_mul_u32_u24 v2, 5120, v5
    v_lshlrev_b32 v3, 5, v6
    v_add_u32 v2, v2, v3
    ds_write_b128 v2, v[8:11] offset:32768
    ds_write_b128 v2, v[12:15] offset:32784
    ds_write_b128 v2, v[16:19] offset:35328
    ds_write_b128 v2, v[20:23] offset:35344
    s_waitcnt lgkmcnt(0)
    s_barrier
    ds_read_b128 v[24:27], v7 offset:32768
    ds_read_b128 v[28:31], v7 offset:37888
    ds_read_b128 v[32:35], v7 offset:43008
    ds_read_b128 v[36:39], v7 offset:48128
    s_mul_i32 s37, s40, 5120
    s_add_u32 s37, s37, 303104
    s_waitcnt lgkmcnt(0)
    v_add_f32 v24, v24, v28
    v_add_f32 v32, v32, v36
    v_add_f32 v24, v24, v32
    v_add_f32 v25, v25, v29
    v_add_f32 v33, v33, v37
    v_add_f32 v25, v25, v33
    v_add_f32 v26, v26, v30
    v_add_f32 v34, v34, v38
    v_add_f32 v26, v26, v34
    v_add_f32 v27, v27, v31
    v_add_f32 v35, v35, v39
    v_add_f32 v27, v27, v35
    buffer_store_dwordx4 v[24:27], v7, s[32:35], s37 offen sc1
    s_endpgm
tail_fin:
    s_nop 4
    s_load_dwordx2 s[4:5], s[0:1], 72
    s_load_dwordx2 s[6:7], s[0:1], 80
    s_sub_u32 s28, s2, 208
    s_lshl_b32 s37, s28, 6
    v_add_u32 v5, s37, v1
    v_lshlrev_b32 v4, 2, v5
    s_waitcnt lgkmcnt(0)
    s_mov_b32 s16, s4
    s_and_b32 s17, s5, 0xffff
    s_mov_b32 s18, 1280
    s_mov_b32 s19, 0x00020000
    s_mov_b32 s20, s6
    s_and_b32 s21, s7, 0xffff
    s_mov_b32 s22, 2560
    s_mov_b32 s23, 0x00020000
    s_mov_b32 s24, s14
    s_and_b32 s25, s15, 0xffff
    s_mov_b32 s26, 1048576
    s_mov_b32 s27, 0x00020000
    s_cmp_ge_u32 s28, 10
    s_cselect_b32 s37, 640, 0
    v_subrev_u32 v2, s37, v5
    v_lshlrev_b32 v2, 1, v2
    buffer_load_ushort v7, v2, s[16:19], 0 offen
    s_mul_i32 s38, s36, 40960
    s_add_u32 s38, s38, 303104
fin_poll:
    s_nop 4
    s_add_u32 s39, s38, 0
    buffer_load_dword v8, v4, s[24:27], s39 offen sc1
    s_add_u32 s39, s38, 5120
    buffer_load_dword v9, v4, s[24:27], s39 offen sc1
    s_add_u32 s39, s38, 10240
    buffer_load_dword v10, v4, s[24:27], s39 offen sc1
    s_add_u32 s39, s38, 15360
    buffer_load_dword v11, v4, s[24:27], s39 offen sc1
    s_add_u32 s39, s38, 20480
    buffer_load_dword v12, v4, s[24:27], s39 offen sc1
    s_add_u32 s39, s38, 25600
    buffer_load_dword v13, v4, s[24:27], s39 offen sc1
    s_add_u32 s39, s38, 30720
    buffer_load_dword v14, v4, s[24:27], s39 offen sc1
    s_add_u32 s39, s38, 35840
    buffer_load_dword v15, v4, s[24:27], s39 offen sc1
    s_mov_b32 s39, 548864
    buffer_load_dword v16, v4, s[24:27], s39 offen sc1
    s_waitcnt vmcnt(0)
    v_max3_u32 v2, v8, v9, v10
    v_max3_u32 v2, v2, v11, v12
    v_max3_u32 v2, v2, v13, v14
    v_max3_u32 v2, v2, v15, v16
    v_cmp_eq_u32 vcc, -1, v2
    s_cbranch_vccz fin_poll_done
    s_sleep 2
    s_branch fin_poll
fin_poll_done:
    s_nop 4
    v_add_f32 v8, v8, v9
    v_add_f32 v10, v10, v11
    v_add_f32 v12, v12, v13
    v_add_f32 v14, v14, v15
    v_add_f32 v8, v8, v10
    v_add_f32 v12, v12, v14
    v_add_f32 v8, v8, v12
    v_lshlrev_b32 v2, 2, v0
    ds_write_b32 v2, v8 offset:0
    s_waitcnt lgkmcnt(0)
    s_barrier
    s_cmp_eq_u32 s36, 0
    s_cbranch_scc0 tail_end
    ds_read_b32 v9, v2 offset:256
    ds_read_b32 v10, v2 offset:512
    ds_read_b32 v11, v2 offset:768
    ds_read_b32 v12, v2 offset:1024
    ds_read_b32 v13, v2 offset:1280
    v_lshlrev_b32 v7, 16, v7
    s_waitcnt lgkmcnt(0)
    v_add_f32 v8, v8, v9
    v_add_f32 v10, v10, v11
    v_add_f32 v12, v12, v13
    v_add_f32 v8, v8, v10
    v_add_f32 v8, v8, v12
    v_cvt_pk_bf16_f32 v8, v8, v8
    v_lshlrev_b32 v8, 16, v8
    v_add_f32 v8, v8, v7
    v_cvt_pk_bf16_f32 v8, v8, v8
    v_lshlrev_b32 v8, 16, v8
    v_add_f32 v8, v8, v16
    v_cvt_pk_bf16_f32 v8, v8, v8
    v_lshlrev_b32 v2, 1, v5
    buffer_store_short v8, v2, s[20:23], 0 offen
tail_end:
    s_endpgm
.section .rodata,"a"
.p2align 6
.amdhsa_kernel attn_kernel
  .amdhsa_next_free_vgpr 124
  .amdhsa_next_free_sgpr 60
  .amdhsa_accum_offset 124
  .amdhsa_group_segment_fixed_size 0
  .amdhsa_kernarg_size 104
  .amdhsa_user_sgpr_count 2
  .amdhsa_user_sgpr_kernarg_segment_ptr 1
  .amdhsa_system_sgpr_workgroup_id_x 1
  .amdhsa_float_denorm_mode_32 3
.end_amdhsa_kernel
.p2align 6
.amdhsa_kernel tail_kernel
  .amdhsa_next_free_vgpr 144
  .amdhsa_next_free_sgpr 48
  .amdhsa_accum_offset 144
  .amdhsa_group_segment_fixed_size 0
  .amdhsa_kernarg_size 104
  .amdhsa_user_sgpr_count 2
  .amdhsa_user_sgpr_kernarg_segment_ptr 1
  .amdhsa_system_sgpr_workgroup_id_x 1
  .amdhsa_float_denorm_mode_32 3
.end_amdhsa_kernel
```
